```python
import torch

def _softmax(x, axis=-1):
    return torch.softmax(x, dim=axis)
def _gelu(x):
    return torch.nn.functional.gelu(x, approximate="tanh")
def _silu(x):
    return torch.nn.functional.silu(x)
def _sigmoid(x):
    return torch.sigmoid(x)
def _layernorm(x, axis=-1, eps=1e-5):
    m = x.mean(dim=axis, keepdim=True)
    v = x.var(dim=axis, keepdim=True, unbiased=False)
    return (x - m) / torch.sqrt(v + eps)
def _scatter_add(tgt, idx, src, axis=0):
    return tgt.clone().index_add_(axis, idx, src)
def _segment_sum(src, seg, n):
    out = torch.zeros((n,) + src.shape[1:], dtype=src.dtype)
    return out.index_add_(0, seg, src)
def _pad(x, pw):
    flat = tuple(v for pair in reversed(pw) for v in pair)
    return torch.nn.functional.pad(x, flat)

kernel_name = 'gather_scatter__edge_featured_mpnn_egc__graph'

def setup_inputs():

    _w = (lambda a: (lambda t: t.to(torch.bfloat16) if t.is_floating_point() else t)(torch.as_tensor(a)))
    N, deg, D, De = 12500, 64, 64, max(4, 1)
    E = N * deg
    return {
        "x": _w((lambda *s: torch.randn(*s, dtype=torch.bfloat16) * 0.2)(N, D)),
        "e_attr": _w((lambda *s: torch.randn(*s, dtype=torch.bfloat16) * 0.2)(E, De)),
        "src": _w((lambda lo, hi, *s: torch.randint(lo, hi, s))(0, N, E).to(torch.int64)),
        "dst": _w((lambda lo, hi, *s: torch.randint(lo, hi, s))(0, N, E).to(torch.int64)),
        "u_w": _w((lambda *s: torch.randn(*s, dtype=torch.bfloat16) * 0.05)(D, D)),
        "v_w": _w((lambda *s: torch.randn(*s, dtype=torch.bfloat16) * 0.05)(D, D)),
        "g_w": _w((lambda *s: torch.randn(*s, dtype=torch.bfloat16) * 0.2)(2 * D + De, D)),
    }

def reference(x, e_attr, src, dst, u_w, v_w, g_w):
    N, D = x.shape
    g_in = torch.concatenate([x[dst], x[src], e_attr], axis=-1)
    eta = _sigmoid(g_in @ g_w)
    hv = x @ v_w
    msg = eta * hv[src]
    agg = _segment_sum(msg, dst, N)
    return _silu(x @ u_w + agg)
```

```asm
; @launch grid=(256,1,1) block=(1024,1,1) lds=154624
.amdgcn_target "amdgcn-amd-amdhsa--gfx950"
.text
.globl gather_scatter__edge_featured_mpnn_egc__graph_kernel
.p2align 8
.type gather_scatter__edge_featured_mpnn_egc__graph_kernel,@function
gather_scatter__edge_featured_mpnn_egc__graph_kernel:
    s_load_dwordx16 s[72:87], s[0:1], 0
    s_load_dwordx4 s[88:91], s[0:1], 64
    s_cmp_ge_u32 s2, 256
    s_cbranch_scc1 L2_end
    v_readfirstlane_b32 s28, v0
    s_sub_u32 s18, s2, 32
    s_cbranch_scc0 L1_go
    s_add_u32 s18, s2, 224
    s_getpc_b64 s[66:67]
L1_pc:
    v_lshlrev_b32 v2, 7, v0
    v_cmp_gt_u32 vcc, L2_last-L1_pc, v2
    s_and_b64 exec, exec, vcc
    s_cbranch_execz L1_go0
    global_load_dword v121, v2, s[66:67]
    s_or_b32 s3, s2, s28
    s_cbranch_scc1 L1_go0
    s_mov_b64 exec, 1
    v_mov_b32 v4, 19402752
    s_mov_b32 s3, 1664525
    v_mov_b32 v3, 1
    v_mov_b32 v5, 0
    s_waitcnt lgkmcnt(0)
    global_load_dword v2, v4, s[90:91] sc1
    s_waitcnt vmcnt(0)
    v_mul_lo_u32 v2, v2, s3
    v_add_u32 v2, 1013904223, v2
    global_store_dwordx2 v5, v[2:3], s[88:89] sc1
    global_store_dword v4, v2, s[90:91] sc1
L1_go0:
    s_mov_b64 exec, -1
L1_go:
    s_mul_i32 s16, s18, 14336
    v_lshlrev_b32 v1, 4, v0
    v_lshlrev_b32 v4, 2, v0
    v_mov_b32 v5, 0
    ds_write_b32 v4, v5
    v_and_b32 v98, 63, v0
    s_lshr_b32 s28, s28, 6
    s_cmp_ge_u32 s28, 14
    s_cbranch_scc1 L1_help0
    v_add_u32 v7, s16, v1
    v_cmp_gt_u32 vcc, 3200000, v7
    v_lshlrev_b32 v2, 1, v7
    s_mov_b64 exec, vcc
    s_waitcnt lgkmcnt(0)
    global_load_dwordx4 v[8:11], v7, s[78:79]
    s_barrier
    global_load_dwordx4 v[12:15], v7, s[76:77]
    global_load_dwordx4 v[16:19], v2, s[74:75]
    global_load_dwordx4 v[20:23], v2, s[74:75] offset:16
    s_branch L1_bin
L1_help0:
    s_setprio 3
    s_and_b32 s29, s2, 7
    s_lshl_b32 s29, s29, 5
    s_lshr_b32 s3, s2, 3
    s_add_u32 s29, s29, s3
    s_lshl_b32 s36, s29, 7
    s_lshr_b32 s38, s16, 1
    s_mov_b32 s35, 91648
    s_cmp_eq_u32 s28, 14
    s_cselect_b32 s38, s38, s36
    s_cselect_b32 s39, 7, 15
    s_cselect_b32 m0, 23040, s35
    s_cselect_b32 s35, 0, 8192
    v_lshrrev_b32 v2, 3, v98
    v_lshlrev_b32 v2, s39, v2
    v_lshrrev_b32 v3, 4, v98
    v_and_b32 v4, 7, v98
    v_xor_b32 v3, v3, v4
    v_lshl_add_u32 v2, v3, 4, v2
    v_add_u32 v2, s38, v2
    s_lshl_b32 s39, 8, s39
    v_lshlrev_b32 v40, 4, v98
    v_add_u32 v41, 4096, v40
    s_mov_b32 s6, 1600000
    s_mov_b32 s7, 0x20000
    s_waitcnt lgkmcnt(0)
    s_mov_b32 s4, s72
    s_mov_b32 s5, s73
    buffer_load_dwordx4 v2, s[4:7], 0 offen lds
    s_add_u32 m0, m0, 1024
    v_xor_b32 v2, 64, v2
    v_add_u32 v2, s39, v2
    buffer_load_dwordx4 v2, s[4:7], 0 offen lds
    s_add_u32 m0, m0, 1024
    v_xor_b32 v2, 64, v2
    v_add_u32 v2, s39, v2
    buffer_load_dwordx4 v2, s[4:7], 0 offen lds
    s_add_u32 m0, m0, 1024
    v_xor_b32 v2, 64, v2
    v_add_u32 v2, s39, v2
    buffer_load_dwordx4 v2, s[4:7], 0 offen lds
    s_add_u32 m0, m0, 1024
    v_xor_b32 v2, 64, v2
    v_add_u32 v2, s39, v2
    buffer_load_dwordx4 v2, s[4:7], 0 offen lds
    s_add_u32 m0, m0, 1024
    v_xor_b32 v2, 64, v2
    v_add_u32 v2, s39, v2
    buffer_load_dwordx4 v2, s[4:7], 0 offen lds
    s_add_u32 m0, m0, 1024
    v_xor_b32 v2, 64, v2
    v_add_u32 v2, s39, v2
    buffer_load_dwordx4 v2, s[4:7], 0 offen lds
    s_add_u32 s24, s84, 8192
    s_addc_u32 s25, s85, 0
    s_add_u32 m0, s35, 6656
    s_cmp_eq_u32 s28, 14
    s_cselect_b32 s24, s24, s82
    s_cselect_b32 s25, s25, s83
    s_cselect_b32 s26, s84, s80
    s_cselect_b32 s27, s85, s81
    global_load_lds_dwordx4 v40, s[24:25] offset:0
    global_load_lds_dwordx4 v40, s[24:25] offset:1024
    global_load_lds_dwordx4 v40, s[24:25] offset:2048
    global_load_lds_dwordx4 v40, s[24:25] offset:3072
    s_add_u32 m0, m0, 4096
    s_nop 0
    global_load_lds_dwordx4 v41, s[24:25] offset:0
    global_load_lds_dwordx4 v41, s[24:25] offset:1024
    global_load_lds_dwordx4 v41, s[24:25] offset:2048
    global_load_lds_dwordx4 v41, s[24:25] offset:3072
    s_barrier
    s_branch L1_help
L1_bin:
    s_mov_b64 s[44:45], vcc
    v_mov_b32 v6, 1
    s_mul_i32 s17, s18, 43008
    s_add_u32 s17, s17, 8388608
    s_mov_b32 s3, 31232
    s_waitcnt vmcnt(3)
    v_lshlrev_b32_sdwa v24, 2, v8 dst_sel:DWORD dst_unused:UNUSED_PAD src0_sel:DWORD src1_sel:BYTE_0
    ds_add_rtn_u32 v28, v24, v6 offset:512
    v_lshlrev_b32_sdwa v25, 2, v9 dst_sel:DWORD dst_unused:UNUSED_PAD src0_sel:DWORD src1_sel:BYTE_0
    ds_add_rtn_u32 v29, v25, v6 offset:512
    v_lshlrev_b32_sdwa v26, 2, v10 dst_sel:DWORD dst_unused:UNUSED_PAD src0_sel:DWORD src1_sel:BYTE_0
    ds_add_rtn_u32 v30, v26, v6 offset:512
    v_lshlrev_b32_sdwa v27, 2, v11 dst_sel:DWORD dst_unused:UNUSED_PAD src0_sel:DWORD src1_sel:BYTE_0
    ds_add_rtn_u32 v31, v27, v6 offset:512
    v_lshrrev_b32 v8, 8, v8
    v_lshl_or_b32 v8, v8, 26, 8
    v_lshrrev_b32 v9, 8, v9
    v_lshl_or_b32 v9, v9, 26, 8
    v_lshrrev_b32 v10, 8, v10
    v_lshl_or_b32 v10, v10, 26, 8
    v_lshrrev_b32 v11, 8, v11
    v_lshl_or_b32 v11, v11, 26, 8
    s_mov_b64 exec, -1
    v_lshlrev_b32 v40, 4, v98
    s_waitcnt lgkmcnt(0)
    s_barrier
    ds_read_b128 v[32:35], v40 offset:512
    s_waitcnt lgkmcnt(0)
    v_add_u32 v41, v32, v33
    v_add_u32 v42, v41, v34
    v_add_u32 v43, v42, v35
    v_add_u32 v44, v42, v35
    s_nop 1
    v_add_u32_dpp v44, v44, v44 row_shr:1 row_mask:0xf bank_mask:0xf bound_ctrl:1
    s_nop 1
    v_add_u32_dpp v44, v44, v44 row_shr:2 row_mask:0xf bank_mask:0xf bound_ctrl:1
    s_nop 1
    v_add_u32_dpp v44, v44, v44 row_shr:4 row_mask:0xf bank_mask:0xf bound_ctrl:1
    s_nop 1
    v_add_u32_dpp v44, v44, v44 row_shr:8 row_mask:0xf bank_mask:0xf bound_ctrl:1
    s_nop 1
    v_add_u32_dpp v44, v44, v44 row_bcast:15 row_mask:0xa bank_mask:0xf
    s_nop 1
    v_add_u32_dpp v44, v44, v44 row_bcast:31 row_mask:0xc bank_mask:0xf
    v_sub_u32 v36, v44, v43
    v_add_u32 v37, v36, v32
    v_add_u32 v38, v36, v41
    v_add_u32 v39, v36, v42
    v_mad_u32_u24 v36, v36, 12, s3
    v_mad_u32_u24 v37, v37, 12, s3
    v_mad_u32_u24 v38, v38, 12, s3
    v_mad_u32_u24 v39, v39, 12, s3
    ds_write_b128 v40, v[36:39] offset:1536
    s_mov_b64 exec, s[44:45]
    s_waitcnt lgkmcnt(0)
    ds_read_b32 v24, v24 offset:1536
    ds_read_b32 v25, v25 offset:1536
    ds_read_b32 v26, v26 offset:1536
    ds_read_b32 v27, v27 offset:1536
    s_mov_b32 s12, s90
    s_mov_b32 s13, s91
    s_mov_b32 s14, 19402880
    s_mov_b32 s15, 0x20000
    s_add_u32 s38, s17, 14336
    s_add_u32 s39, s17, 28672
    s_waitcnt lgkmcnt(0)
    v_mad_u32_u24 v24, v28, 12, v24
    v_mad_u32_u24 v25, v29, 12, v25
    v_mad_u32_u24 v26, v30, 12, v26
    v_mad_u32_u24 v27, v31, 12, v27
    s_waitcnt vmcnt(2)
    v_lshl_add_u32 v12, v12, 3, v8
    ds_write_b32 v24, v12 offset:8
    v_lshl_add_u32 v13, v13, 3, v9
    ds_write_b32 v25, v13 offset:8
    v_lshl_add_u32 v14, v14, 3, v10
    ds_write_b32 v26, v14 offset:8
    v_lshl_add_u32 v15, v15, 3, v11
    ds_write_b32 v27, v15 offset:8
    s_waitcnt vmcnt(1)
    ds_write2_b32 v24, v16, v17 offset0:0 offset1:1
    ds_write2_b32 v25, v18, v19 offset0:0 offset1:1
    s_waitcnt vmcnt(0)
    ds_write2_b32 v26, v20, v21 offset0:0 offset1:1
    ds_write2_b32 v27, v22, v23 offset0:0 offset1:1
    s_mov_b64 exec, -1
    s_cmp_ge_u32 s18, 224
    s_waitcnt lgkmcnt(0)
    s_barrier
    s_cbranch_scc1 L1_join
    ds_read_b128 v[8:11], v1 offset:31232
    ds_read_b128 v[12:15], v1 offset:45568
    ds_read_b128 v[16:19], v1 offset:59904
    s_waitcnt lgkmcnt(2)
    buffer_store_dwordx4 v[8:11], v1, s[12:15], s17 offen sc1
    s_waitcnt lgkmcnt(1)
    buffer_store_dwordx4 v[12:15], v1, s[12:15], s38 offen sc1
    s_waitcnt lgkmcnt(0)
    buffer_store_dwordx4 v[16:19], v1, s[12:15], s39 offen sc1
L1_join:
    v_lshlrev_b32 v2, 2, v98
    v_mul_u32_u24 v3, 464, v98
    ds_write_b32 v2, v3 offset:0
    s_and_b32 s29, s2, 7
    s_lshl_b32 s29, s29, 5
    s_lshr_b32 s3, s2, 3
    s_add_u32 s29, s29, s3
    v_and_b32 v2, 31, v98
    v_lshlrev_b32 v96, 3, v2
    s_mov_b32 s10, 3200256
    s_mov_b32 s11, 0xc00000
    s_mov_b32 s22, 1600000
    s_mov_b32 s23, 0x20000
    s_mov_b32 s20, s86
    s_mov_b32 s21, s87
    s_mov_b32 s8, s90
    s_or_b32 s9, s91, 0x80000000
    s_mov_b32 s37, 0x1fff8
    v_mov_b32 v99, 4
    v_and_b32 v1, 31, v98
    v_lshrrev_b32 v2, 5, v98
    v_bfe_u32 v3, v1, 2, 1
    v_cmp_eq_u32 vcc, v3, v2
    v_mov_b32 v103, 0x3f803f80
    v_and_b32 v100, 1, v1
    v_cndmask_b32 v103, 0, v103, vcc
    v_cmp_eq_u32 vcc, 0, v100
    v_lshrrev_b32 v101, 3, v1
    v_bfe_u32 v102, v1, 1, 1
    v_cndmask_b32 v86, 0, v103, vcc
    v_cndmask_b32 v87, v103, 0, vcc
    v_cmp_eq_u32 vcc, v2, v100
    v_lshl_add_u32 v101, v101, 1, v102
    v_lshlrev_b32 v123, 3, v101
    v_mov_b32 v101, 45472
    v_cndmask_b32 v123, v101, v123, vcc
    v_cndmask_b32 v92, 0, 2, vcc
    v_lshlrev_b32 v125, 3, v3
    v_mov_b32 v94, 32
    v_mov_b32 v95, 32
    s_mov_b32 s30, 0
    s_movk_i32 s31, 45
    v_mov_b32 v97, 0
    s_mov_b32 s32, 0
    s_cmp_eq_u32 s28, 14
    s_cselect_b32 s35, s18, 224
    s_lshl_b32 s3, s18, 11
    s_add_u32 s3, s3, 18874368
    v_lshlrev_b32 v3, 4, v98
    v_lshlrev_b32 v2, 3, v98
    v_mov_b32 v1, 272
    s_cmp_ge_u32 s35, 224
    s_waitcnt vmcnt(0) lgkmcnt(0)
    s_barrier
    s_cbranch_scc1 L1_noff
    buffer_store_dwordx4 v[4:7], v3, s[12:15], s3 offen sc1
    buffer_store_dwordx4 v[8:11], v3, s[12:15], s3 offen offset:1024 sc1
L1_noff:
    s_setprio 0
    ds_read_b32 v1, v1
    ds_read_b64 v[88:89], v2 offset:2560
    s_cmp_ge_u32 s28, 8
    s_waitcnt lgkmcnt(0)
    v_readfirstlane_b32 s43, v1
    s_cbranch_scc1 L2_gemm
L2_gemmr:
    s_mul_i32 s42, s43, 0x9e3779b1
    s_lshr_b32 s42, s42, 24
    s_mov_b32 s32, 0
    v_mul_u32_u24 v2, 57, v98
    v_lshrrev_b32 v2, 9, v2
    v_min_u32 v2, 6, v2
    s_mul_i32 s3, s28, 7
    v_add_u32 v1, s3, v2
    s_lshl_b32 s3, s29, 3
    s_add_u32 s3, s3, 18874368
    v_lshl_add_u32 v124, v1, 12, s3
    v_mul_u32_u24 v2, 9, v2
    v_sub_u32 v2, v98, v2
    v_add_u32 v2, s30, v2
    v_mul_u32_u24 v1, 86016, v1
    v_add_u32 v1, 8388608, v1
    v_mad_u32_u24 v50, v2, 12, v1
    v_add_u32 v51, 43008, v50
    s_add_u32 s39, s30, s31
    s_mov_b32 s3, 1073741824
    v_mov_b32 v1, s3
    v_writelane_b32 v2, s3, 63
    s_mov_b32 s41, 40000
    s_waitcnt vmcnt(0)
    s_barrier
    s_cmp_ge_u32 s18, 224
    s_cbranch_scc1 L1_idle
L1_idler:
L2_poll:
    s_mov_b64 s[46:47], -1
    s_mov_b64 s[48:49], -1
L2_repoll:
    s_mov_b64 exec, s[46:47]
    buffer_load_dwordx2 v[44:45], v124, s[12:15], 0 offen sc1
    s_mov_b64 exec, s[48:49]
    buffer_load_dwordx2 v[46:47], v124, s[12:15], 0 offen offset:2048 sc1
    s_mov_b64 exec, -1
    s_waitcnt vmcnt(0)
    v_cmp_ne_u32 s[46:47], s43, v45
    v_cmp_ne_u32 s[48:49], s43, v47
    v_cmp_ne_u32_sdwa s[50:51], s42, v44 src0_sel:DWORD src1_sel:BYTE_3
    v_cmp_ne_u32_sdwa s[52:53], s42, v46 src0_sel:DWORD src1_sel:BYTE_3
    s_or_b64 s[46:47], s[46:47], s[50:51]
    s_or_b64 s[48:49], s[48:49], s[52:53]
    s_or_b64 vcc, s[46:47], s[48:49]
    s_cbranch_scc0 L2_ready
    s_sleep 4
    s_sub_u32 s41, s41, 1
    s_cbranch_scc0 L2_repoll
    v_cndmask_b32 v44, v44, 0, s[46:47]
    v_cndmask_b32 v46, v46, 0, s[48:49]
L2_ready:
    v_bfe_u32 v45, v44, 12, 12
    v_and_b32 v44, 0xfff, v44
    v_min_u32 v48, s39, v45
    v_mad_u32_u24 v50, v44, 12, v50
    v_sub_u32 v48, v48, v2
    v_bfe_u32 v47, v46, 12, 12
    v_and_b32 v46, 0xfff, v46
    v_min_u32 v49, s39, v47
    v_mad_u32_u24 v51, v46, 12, v51
    v_sub_u32 v49, v49, v2
    v_cmp_lt_i32 s[46:47], 0, v48
    v_cmp_lt_i32 s[48:49], 0, v49
    v_cmp_lt_i32 s[50:51], 9, v48
    v_cmp_lt_i32 s[52:53], 9, v49
    v_cmp_lt_i32 s[54:55], 18, v48
    v_cmp_lt_i32 s[56:57], 18, v49
    v_cndmask_b32 v7, v1, v50, s[46:47]
    v_cndmask_b32 v11, v1, v51, s[48:49]
    v_cndmask_b32 v15, v1, v50, s[50:51]
    v_cndmask_b32 v19, v1, v51, s[52:53]
    v_cndmask_b32 v23, v1, v50, s[54:55]
    v_cndmask_b32 v27, v1, v51, s[56:57]
    s_cmp_eq_u64 s[54:55], 0
    s_cbranch_scc1 L2_skl4
    buffer_load_dwordx3 v[20:22], v23, s[12:15], 0 offen offset:216 sc1
L2_skl4:
    s_cmp_eq_u64 s[56:57], 0
    s_cbranch_scc1 L2_skl5
    buffer_load_dwordx3 v[24:26], v27, s[12:15], 0 offen offset:216 sc1
L2_skl5:
    buffer_load_dwordx3 v[4:6], v7, s[12:15], 0 offen offset:0 sc1
    buffer_load_dwordx3 v[8:10], v11, s[12:15], 0 offen offset:0 sc1
    buffer_load_dwordx3 v[12:14], v15, s[12:15], 0 offen offset:108 sc1
    buffer_load_dwordx3 v[16:18], v19, s[12:15], 0 offen offset:108 sc1
    v_max_i32 v100, v48, v49
    v_cmp_lt_i32 vcc, 27, v100
    s_mov_b32 s40, 0
    v_max_u32 v100, v45, v47
    s_cbranch_vccnz L2_xtra1
L2_xtra1r:
    v_cmp_lt_u32 vcc, s39, v100
    s_cbranch_vccnz L2_more
L2_morer:
    s_cmp_eq_u64 s[54:55], 0
    s_cbranch_scc1 L2_skc4
    s_waitcnt vmcnt(4)
    s_mov_b64 exec, s[54:55]
    v_lshrrev_b32 v23, 24, v22
    ds_add_rtn_u32 v23, v23, v99 offset:0
L2_skc4:
    s_cmp_eq_u64 s[56:57], 0
    s_cbranch_scc1 L2_skc5
    s_waitcnt vmcnt(4)
    s_mov_b64 exec, s[56:57]
    v_lshrrev_b32 v27, 24, v26
    ds_add_rtn_u32 v27, v27, v99 offset:0
L2_skc5:
    s_waitcnt vmcnt(3)
    s_mov_b64 exec, s[46:47]
    v_lshrrev_b32 v7, 24, v6
    ds_add_rtn_u32 v7, v7, v99 offset:0
    s_waitcnt vmcnt(2)
    s_mov_b64 exec, s[48:49]
    v_lshrrev_b32 v11, 24, v10
    ds_add_rtn_u32 v11, v11, v99 offset:0
    s_waitcnt vmcnt(1)
    s_mov_b64 exec, s[50:51]
    v_lshrrev_b32 v15, 24, v14
    ds_add_rtn_u32 v15, v15, v99 offset:0
    s_waitcnt vmcnt(0)
    s_mov_b64 exec, s[52:53]
    v_lshrrev_b32 v19, 24, v18
    ds_add_rtn_u32 v19, v19, v99 offset:0
    s_cmp_lt_u32 s28, 11
    s_cbranch_scc1 L2_nopf
    s_mov_b64 exec, -1
    s_lshr_b32 s3, s2, 3
    s_lshl_b32 s36, s28, 5
    s_add_u32 s3, s3, s36
    s_mul_i32 s3, s3, 6272
    v_min_u32 v2, 48, v98
    v_lshlrev_b32 v2, 7, v2
    buffer_load_dword v121, v2, s[12:15], s3 offen offset:256 sc1
L2_nopf:
    s_waitcnt lgkmcnt(0)
    s_mov_b64 exec, s[46:47]
    v_min_u32 v100, 22732, v7
    v_and_b32 v1, s37, v6
    v_lshlrev_b32 v102, 1, v100
    ds_write_b32 v100, v1 offset:6656
    ds_write_b64 v102, v[4:5] offset:29488
    s_mov_b64 exec, s[48:49]
    v_min_u32 v101, 22732, v11
    v_and_b32 v2, s37, v10
    v_lshlrev_b32 v103, 1, v101
    ds_write_b32 v101, v2 offset:6656
    ds_write_b64 v103, v[8:9] offset:29488
    s_mov_b64 exec, s[50:51]
    v_min_u32 v100, 22732, v15
    v_and_b32 v1, s37, v14
    v_lshlrev_b32 v102, 1, v100
    ds_write_b32 v100, v1 offset:6656
    ds_write_b64 v102, v[12:13] offset:29488
    s_mov_b64 exec, s[52:53]
    v_min_u32 v101, 22732, v19
    v_and_b32 v2, s37, v18
    v_lshlrev_b32 v103, 1, v101
    ds_write_b32 v101, v2 offset:6656
    ds_write_b64 v103, v[16:17] offset:29488
    s_cmp_eq_u64 s[54:55], 0
    s_cbranch_scc1 L2_sks4
    s_mov_b64 exec, s[54:55]
    v_min_u32 v100, 22732, v23
    v_and_b32 v1, s37, v22
    v_lshlrev_b32 v102, 1, v100
    ds_write_b32 v100, v1 offset:6656
    ds_write_b64 v102, v[20:21] offset:29488
L2_sks4:
    s_cmp_eq_u64 s[56:57], 0
    s_cbranch_scc1 L2_sks5
    s_mov_b64 exec, s[56:57]
    v_min_u32 v101, 22732, v27
    v_and_b32 v2, s37, v26
    v_lshlrev_b32 v103, 1, v101
    ds_write_b32 v101, v2 offset:6656
    ds_write_b64 v103, v[24:25] offset:29488
L2_sks5:
    s_cmp_lg_u32 s40, 0
    s_cbranch_scc1 L2_xtra2
L2_xtra2r:
    s_mov_b64 exec, -1
    v_lshlrev_b32 v2, 2, v98
    v_mov_b32 v3, 256
    v_mul_u32_u24 v107, 464, v98
    v_mul_u32_u24 v119, 768, v98
    v_add_u32 v119, 99840, v119
    v_subrev_u32 v101, 28, v107
    s_lshl_b32 s3, s28, 5
    v_add_u32 v118, s3, v107
    v_lshrrev_b32 v116, 5, v98
    s_lshl_b32 s38, s28, 2
    s_xor_b32 s38, s38, 32
    v_mov_b64 v[108:109], 0
    s_waitcnt lgkmcnt(0)
    s_barrier
    ds_read_b32 v1, v2 offset:0
    ds_read_b32 v3, v3
    s_waitcnt lgkmcnt(1)
    v_add_u32 v106, s38, v1
    v_sub_u32 v1, v1, v101
    v_lshrrev_b32 v100, 5, v1
    s_waitcnt lgkmcnt(0)
    v_readfirstlane_b32 s34, v3
    v_add_u32_dpp v2, v100, v100 row_shr:1 row_mask:0xf bank_mask:0xf bound_ctrl:1
    v_add_u32_dpp v2, v100, v2 row_shr:2 row_mask:0xf bank_mask:0xf bound_ctrl:1
    v_add_u32_dpp v2, v100, v2 row_shr:3 row_mask:0xf bank_mask:0xf bound_ctrl:1
    v_cmp_lt_u32 vcc, 14, v100
    s_nop 0
    v_add_u32_dpp v2, v2, v2 row_shr:4 row_mask:0xf bank_mask:0xf bound_ctrl:1
    s_nop 1
    v_add_u32_dpp v2, v2, v2 row_shr:8 row_mask:0xf bank_mask:0xf bound_ctrl:1
    s_nop 1
    v_add_u32_dpp v2, v2, v2 row_bcast:15 row_mask:0xa bank_mask:0xf
    s_nop 1
    v_add_u32_dpp v2, v2, v2 row_bcast:31 row_mask:0xc bank_mask:0xf
    v_sub_u32 v1, v2, v100
    v_readlane_b32 s36, v2, 63
    v_writelane_b32 v100, 1, 49
    v_add_lshl_u32 v101, v1, s28, 3
    s_cbranch_vccnz L2_compact
    v_cmp_lt_u32 vcc, s28, v100
    s_mov_b64 exec, vcc
    ds_write_b64 v101, v[118:119] offset:512
L2_fits:
    s_mov_b64 exec, -1
    v_lshl_add_u32 v107, v100, 5, v107
    v_cmp_lt_u32 vcc, v106, v107
    v_lshlrev_b32 v107, 1, v106
    s_mov_b64 exec, vcc
    ds_write_b32 v106, v108 offset:6656
    ds_write_b64 v107, v[108:109] offset:29488
    s_mov_b64 exec, -1
    s_add_u32 s36, s36, 1
    s_lshr_b32 s35, s36, 5
    s_bfe_u32 s3, s36, 0x40001
    s_mul_i32 s36, s35, s28
    s_min_u32 s38, s3, s28
    s_add_u32 s36, s36, s38
    s_cmp_lt_u32 s28, s3
    s_addc_u32 s35, s35, 0
    s_lshl_b32 s3, s36, 4
    s_add_u32 s3, s3, 512
    v_lshl_add_u32 v116, v116, 3, s3
    v_add_u32 v117, s3, v125
    s_cmp_eq_u32 s35, 0
    s_waitcnt lgkmcnt(0)
    s_barrier
    s_cbranch_scc1 L2_done
    ds_read2_b32 v[118:119], v116 offset0:0 offset1:1
    ds_read_b32 v122, v117 offset:0
    s_waitcnt lgkmcnt(1)
    ds_read_b128 v[4:7], v118 offset:6656
    ds_read_b128 v[8:11], v118 offset:6672
    s_waitcnt lgkmcnt(2)
    v_mad_u32_u24 v122, v122, v92, v123
    v_add_u32 v112, v119, v96
    ds_read_b64 v[84:85], v122 offset:29488
    ds_read_b64 v[90:91], v112 offset:512
    ds_read2_b32 v[118:119], v116 offset0:4 offset1:5
    s_waitcnt lgkmcnt(3)
    buffer_load_dword v20, v4, s[8:11], 0 offen offset:0
    buffer_load_dword v21, v4, s[8:11], 0 offen offset:4
    buffer_load_dword v22, v5, s[8:11], 0 offen offset:0
    buffer_load_dword v23, v5, s[8:11], 0 offen offset:4
    buffer_load_dword v24, v6, s[8:11], 0 offen offset:0
    buffer_load_dword v25, v6, s[8:11], 0 offen offset:4
    buffer_load_dword v26, v7, s[8:11], 0 offen offset:0
    buffer_load_dword v27, v7, s[8:11], 0 offen offset:4
    buffer_load_dword v28, v8, s[8:11], 0 offen offset:0
    buffer_load_dword v29, v8, s[8:11], 0 offen offset:4
    buffer_load_dword v30, v9, s[8:11], 0 offen offset:0
    buffer_load_dword v31, v9, s[8:11], 0 offen offset:4
    buffer_load_dword v32, v10, s[8:11], 0 offen offset:0
    buffer_load_dword v33, v10, s[8:11], 0 offen offset:4
    buffer_load_dword v34, v11, s[8:11], 0 offen offset:0
    buffer_load_dword v35, v11, s[8:11], 0 offen offset:4
    v_mov_b32 v113, v112
    v_mov_b32 v104, 1.0
    v_mov_b32 v105, 1.0
    v_mov_b64 v[50:51], 0
    v_mov_b64 v[106:107], 0
    s_waitcnt lgkmcnt(0)
    ds_read_b128 v[4:7], v118 offset:6656
    ds_read_b128 v[8:11], v118 offset:6672
    ds_read2_b32 v[118:119], v116 offset0:8 offset1:5
    ds_read_b32 v122, v117 offset:16
    s_cmp_lg_u32 s32, 0
    s_cbranch_scc1 L2_safe
    s_setprio 3
L2_loopf:
    s_cmp_gt_u32 s35, 6
    s_cbranch_scc1 L2_prf
    s_setprio 2
    s_cmp_gt_u32 s35, 4
    s_cbranch_scc1 L2_prf
    s_setprio 1
    s_cmp_gt_u32 s35, 2
    s_cbranch_scc1 L2_prf
    s_setprio 0
L2_prf:
    s_waitcnt vmcnt(0) lgkmcnt(0)
    v_mfma_f32_32x32x16_bf16 v[52:67], v[84:87], v[88:91], v[20:35]
    v_rcp_f32 v106, v104
    v_rcp_f32 v107, v105
    v_max3_f32 v97, v97, v104, v105
    v_mul_f32 v106, v106, v50
    v_mul_f32 v107, v107, v51
    v_cvt_f64_f32 v[108:109], v106
    v_cvt_f64_f32 v[110:111], v107
    ds_add_f64 v113, v[108:109] offset:0
    ds_add_f64 v113, v[110:111] offset:256
    v_mad_u32_u24 v122, v122, v92, v123
    v_add_u32 v113, v119, v96
    ds_read_b64 v[84:85], v122 offset:29488
    ds_read_b64 v[90:91], v113 offset:512
    s_cmp_eq_u32 s35, 1
    s_cbranch_scc1 L2_nlf0
    buffer_load_dword v36, v4, s[8:11], 0 offen offset:0
    buffer_load_dword v37, v4, s[8:11], 0 offen offset:4
    buffer_load_dword v38, v5, s[8:11], 0 offen offset:0
    buffer_load_dword v39, v5, s[8:11], 0 offen offset:4
    buffer_load_dword v40, v6, s[8:11], 0 offen offset:0
    buffer_load_dword v41, v6, s[8:11], 0 offen offset:4
    buffer_load_dword v42, v7, s[8:11], 0 offen offset:0
    buffer_load_dword v43, v7, s[8:11], 0 offen offset:4
    buffer_load_dword v44, v8, s[8:11], 0 offen offset:0
    buffer_load_dword v45, v8, s[8:11], 0 offen offset:4
    buffer_load_dword v46, v9, s[8:11], 0 offen offset:0
    buffer_load_dword v47, v9, s[8:11], 0 offen offset:4
    buffer_load_dword v48, v10, s[8:11], 0 offen offset:0
    buffer_load_dword v49, v10, s[8:11], 0 offen offset:4
    buffer_load_dword v50, v11, s[8:11], 0 offen offset:0
    buffer_load_dword v51, v11, s[8:11], 0 offen offset:4
L2_nlf0:
    ds_read_b128 v[4:7], v118 offset:6656
    ds_read_b128 v[8:11], v118 offset:6672
    ds_read2_b32 v[118:119], v116 offset0:12 offset1:9
    ds_read_b32 v122, v117 offset:32
    v_lshlrev_b64 v[20:21], 16, v[20:21]
    v_lshlrev_b64 v[22:23], 16, v[22:23]
    v_lshlrev_b64 v[24:25], 16, v[24:25]
    v_lshlrev_b64 v[26:27], 16, v[26:27]
    v_lshlrev_b64 v[28:29], 16, v[28:29]
    v_lshlrev_b64 v[30:31], 16, v[30:31]
    v_lshlrev_b64 v[32:33], 16, v[32:33]
    v_lshlrev_b64 v[34:35], 16, v[34:35]
    v_exp_f32 v52, v52
    v_exp_f32 v53, v53
    v_exp_f32 v54, v54
    v_exp_f32 v55, v55
    v_pk_add_f32 v[104:105], v[52:53], 1.0 op_sel_hi:[1,0]
    v_exp_f32 v56, v56
    v_exp_f32 v57, v57
    v_pk_fma_f32 v[22:23], v[22:23], v[104:105], v[20:21]
    v_pk_fma_f32 v[104:105], v[104:105], v[54:55], v[104:105]
    v_pk_fma_f32 v[22:23], v[20:21], v[54:55], v[22:23]
    v_exp_f32 v58, v58
    v_exp_f32 v59, v59
    v_pk_fma_f32 v[24:25], v[24:25], v[104:105], v[22:23]
    v_pk_fma_f32 v[104:105], v[104:105], v[56:57], v[104:105]
    v_pk_fma_f32 v[24:25], v[22:23], v[56:57], v[24:25]
    v_exp_f32 v60, v60
    v_exp_f32 v61, v61
    v_pk_fma_f32 v[26:27], v[26:27], v[104:105], v[24:25]
    v_pk_fma_f32 v[104:105], v[104:105], v[58:59], v[104:105]
    v_pk_fma_f32 v[26:27], v[24:25], v[58:59], v[26:27]
    v_exp_f32 v62, v62
    v_exp_f32 v63, v63
    v_pk_fma_f32 v[28:29], v[28:29], v[104:105], v[26:27]
    v_pk_fma_f32 v[104:105], v[104:105], v[60:61], v[104:105]
    v_pk_fma_f32 v[28:29], v[26:27], v[60:61], v[28:29]
    v_exp_f32 v64, v64
    v_exp_f32 v65, v65
    v_pk_fma_f32 v[30:31], v[30:31], v[104:105], v[28:29]
    v_pk_fma_f32 v[104:105], v[104:105], v[62:63], v[104:105]
    v_pk_fma_f32 v[30:31], v[28:29], v[62:63], v[30:31]
    v_exp_f32 v66, v66
    v_exp_f32 v67, v67
    v_pk_fma_f32 v[32:33], v[32:33], v[104:105], v[30:31]
    v_pk_fma_f32 v[104:105], v[104:105], v[64:65], v[104:105]
    v_pk_fma_f32 v[32:33], v[30:31], v[64:65], v[32:33]
    v_pk_fma_f32 v[34:35], v[34:35], v[104:105], v[32:33]
    v_pk_fma_f32 v[104:105], v[104:105], v[66:67], v[104:105]
    v_pk_fma_f32 v[34:35], v[32:33], v[66:67], v[34:35]
    s_sub_u32 s35, s35, 1
    s_cmp_eq_u32 s35, 0
    s_cbranch_scc1 L2_x0f
    s_waitcnt vmcnt(0) lgkmcnt(0)
    v_mfma_f32_32x32x16_bf16 v[52:67], v[84:87], v[88:91], v[36:51]
    v_rcp_f32 v106, v104
    v_rcp_f32 v107, v105
    v_max3_f32 v97, v97, v104, v105
    v_mul_f32 v106, v106, v34
    v_mul_f32 v107, v107, v35
    v_cvt_f64_f32 v[108:109], v106
    v_cvt_f64_f32 v[110:111], v107
    ds_add_f64 v112, v[108:109] offset:0
    ds_add_f64 v112, v[110:111] offset:256
    v_mad_u32_u24 v122, v122, v92, v123
    v_add_u32 v112, v119, v96
    ds_read_b64 v[84:85], v122 offset:29488
    ds_read_b64 v[90:91], v112 offset:512
    s_cmp_eq_u32 s35, 1
    s_cbranch_scc1 L2_nlf1
    buffer_load_dword v20, v4, s[8:11], 0 offen offset:0
    buffer_load_dword v21, v4, s[8:11], 0 offen offset:4
    buffer_load_dword v22, v5, s[8:11], 0 offen offset:0
    buffer_load_dword v23, v5, s[8:11], 0 offen offset:4
    buffer_load_dword v24, v6, s[8:11], 0 offen offset:0
    buffer_load_dword v25, v6, s[8:11], 0 offen offset:4
    buffer_load_dword v26, v7, s[8:11], 0 offen offset:0
    buffer_load_dword v27, v7, s[8:11], 0 offen offset:4
    buffer_load_dword v28, v8, s[8:11], 0 offen offset:0
    buffer_load_dword v29, v8, s[8:11], 0 offen offset:4
    buffer_load_dword v30, v9, s[8:11], 0 offen offset:0
    buffer_load_dword v31, v9, s[8:11], 0 offen offset:4
    buffer_load_dword v32, v10, s[8:11], 0 offen offset:0
    buffer_load_dword v33, v10, s[8:11], 0 offen offset:4
    buffer_load_dword v34, v11, s[8:11], 0 offen offset:0
    buffer_load_dword v35, v11, s[8:11], 0 offen offset:4
L2_nlf1:
    ds_read_b128 v[4:7], v118 offset:6656
    ds_read_b128 v[8:11], v118 offset:6672
    ds_read2_b32 v[118:119], v116 offset0:16 offset1:13
    ds_read_b32 v122, v117 offset:48
    v_lshl_add_u64 v[116:117], v[116:117], 0, v[94:95]
    v_lshlrev_b64 v[36:37], 16, v[36:37]
    v_lshlrev_b64 v[38:39], 16, v[38:39]
    v_lshlrev_b64 v[40:41], 16, v[40:41]
    v_lshlrev_b64 v[42:43], 16, v[42:43]
    v_lshlrev_b64 v[44:45], 16, v[44:45]
    v_lshlrev_b64 v[46:47], 16, v[46:47]
    v_lshlrev_b64 v[48:49], 16, v[48:49]
    v_lshlrev_b64 v[50:51], 16, v[50:51]
    v_exp_f32 v52, v52
    v_exp_f32 v53, v53
    v_exp_f32 v54, v54
    v_exp_f32 v55, v55
    v_pk_add_f32 v[104:105], v[52:53], 1.0 op_sel_hi:[1,0]
    v_exp_f32 v56, v56
    v_exp_f32 v57, v57
    v_pk_fma_f32 v[38:39], v[38:39], v[104:105], v[36:37]
    v_pk_fma_f32 v[104:105], v[104:105], v[54:55], v[104:105]
    v_pk_fma_f32 v[38:39], v[36:37], v[54:55], v[38:39]
    v_exp_f32 v58, v58
    v_exp_f32 v59, v59
    v_pk_fma_f32 v[40:41], v[40:41], v[104:105], v[38:39]
    v_pk_fma_f32 v[104:105], v[104:105], v[56:57], v[104:105]
    v_pk_fma_f32 v[40:41], v[38:39], v[56:57], v[40:41]
    v_exp_f32 v60, v60
    v_exp_f32 v61, v61
    v_pk_fma_f32 v[42:43], v[42:43], v[104:105], v[40:41]
    v_pk_fma_f32 v[104:105], v[104:105], v[58:59], v[104:105]
    v_pk_fma_f32 v[42:43], v[40:41], v[58:59], v[42:43]
    v_exp_f32 v62, v62
    v_exp_f32 v63, v63
    v_pk_fma_f32 v[44:45], v[44:45], v[104:105], v[42:43]
    v_pk_fma_f32 v[104:105], v[104:105], v[60:61], v[104:105]
    v_pk_fma_f32 v[44:45], v[42:43], v[60:61], v[44:45]
    v_exp_f32 v64, v64
    v_exp_f32 v65, v65
    v_pk_fma_f32 v[46:47], v[46:47], v[104:105], v[44:45]
    v_pk_fma_f32 v[104:105], v[104:105], v[62:63], v[104:105]
    v_pk_fma_f32 v[46:47], v[44:45], v[62:63], v[46:47]
    v_exp_f32 v66, v66
    v_exp_f32 v67, v67
    v_pk_fma_f32 v[48:49], v[48:49], v[104:105], v[46:47]
    v_pk_fma_f32 v[104:105], v[104:105], v[64:65], v[104:105]
    v_pk_fma_f32 v[48:49], v[46:47], v[64:65], v[48:49]
    v_pk_fma_f32 v[50:51], v[50:51], v[104:105], v[48:49]
    v_pk_fma_f32 v[104:105], v[104:105], v[66:67], v[104:105]
    v_pk_fma_f32 v[50:51], v[48:49], v[66:67], v[50:51]
    s_sub_u32 s35, s35, 1
    s_cmp_eq_u32 s35, 0
    s_cbranch_scc0 L2_loopf
    v_mov_b64 v[34:35], v[50:51]
    v_mov_b32 v112, v113
L2_x0f:
    v_rcp_f32 v106, v104
    v_rcp_f32 v107, v105
    v_max3_f32 v97, v97, v104, v105
    v_mul_f32 v106, v106, v34
    v_mul_f32 v107, v107, v35
    v_cvt_f64_f32 v[108:109], v106
    v_cvt_f64_f32 v[110:111], v107
    ds_add_f64 v112, v[108:109] offset:0
    ds_add_f64 v112, v[110:111] offset:256
    s_setprio 0
L2_done:
    v_cmp_lt_f32 vcc, 0x5f800000, v97
    s_cbranch_vccz L2_okd
    v_mov_b32 v2, 260
    ds_write_b32 v2, v99
L2_okd:
    v_lshrrev_b32 v2, 4, v0
    v_and_b32 v3, 15, v0
    v_min_u32 v1, 49, v2
    v_mul_u32_u24 v1, 768, v1
    v_lshl_add_u32 v1, v3, 5, v1
    v_add_u32 v1, 99840, v1
    v_lshlrev_b32 v2, 15, v2
    v_lshl_add_u32 v2, v3, 3, v2
    s_lshl_b32 s3, s29, 7
    v_add_u32 v2, s3, v2
    s_mov_b32 s3, 3216550459
    s_waitcnt vmcnt(0) lgkmcnt(0)
    s_barrier
    s_cmp_eq_u32 s34, 0
    s_cbranch_scc1 L2_epi
    s_add_u32 s30, s30, s31
    s_movk_i32 s31, 45
    s_branch L2_pass
L2_epi:
    ds_read_b128 v[68:71], v1
    ds_read_b128 v[72:75], v1 offset:16
    s_waitcnt lgkmcnt(0)
    v_cvt_f32_f64 v52, v[68:69]
    v_cvt_f32_f64 v53, v[70:71]
    v_cvt_f32_f64 v54, v[72:73]
    v_cvt_f32_f64 v55, v[74:75]
    v_mul_f32 v68, s3, v52
    v_mul_f32 v69, s3, v53
    v_mul_f32 v70, s3, v54
    v_mul_f32 v71, s3, v55
    v_exp_f32 v68, v68
    v_exp_f32 v69, v69
    v_exp_f32 v70, v70
    v_exp_f32 v71, v71
    v_mul_f32 v100, 0, v52
    v_add_f32 v68, 1.0, v68
    v_add_f32 v69, 1.0, v69
    v_add_f32 v70, 1.0, v70
    v_add_f32 v71, 1.0, v71
    v_rcp_f32 v68, v68
    v_rcp_f32 v69, v69
    v_rcp_f32 v70, v70
    v_rcp_f32 v71, v71
    v_fmac_f32 v100, 0, v53
    v_mul_f32 v68, v68, v52
    v_mul_f32 v69, v69, v53
    v_mul_f32 v70, v70, v54
    v_mul_f32 v71, v71, v55
    v_cvt_pk_bf16_f32 v76, v68, v69
    v_cvt_pk_bf16_f32 v77, v70, v71
    buffer_store_dwordx2 v[76:77], v2, s[20:23], 0 offen
    s_cmp_lg_u32 s32, 0
    s_cbranch_scc1 L2_end
    v_fmac_f32 v100, 0, v54
    v_fmac_f32 v100, 0, v55
    v_cmp_u_f32 vcc, v100, v100
    v_mov_b32 v2, 260
    s_cbranch_vccz L2_oke
    ds_write_b32 v2, v99
L2_oke:
    s_waitcnt lgkmcnt(0)
    s_barrier
    ds_read_b32 v1, v2
    s_waitcnt lgkmcnt(0)
    v_readfirstlane_b32 s3, v1
    s_cmp_eq_u32 s3, 0
    s_cbranch_scc1 L2_end
    s_mov_b32 s32, 1
    s_branch L2_start
L2_end:
    s_endpgm
L1_help:
    s_mov_b32 s12, s90
    s_mov_b32 s13, s91
    s_mov_b32 s14, 19402880
    s_mov_b32 s15, 0x20000
    v_and_b32 v2, 63, v0
    v_lshrrev_b32 v7, 4, v2
    v_and_b32 v6, 15, v2
    s_sub_u32 s36, s28, 14
    s_lshl_b32 s3, s36, 13
    s_add_u32 s3, s3, 138240
    s_mul_i32 s36, s36, 28
    v_add3_u32 v3, s36, v6, 0
    v_bfe_u32 v4, v3, 1, 3
    v_xor_b32 v4, v4, v7
    v_lshlrev_b32 v3, 7, v3
    v_lshl_add_u32 v8, v4, 4, v3
    v_xor_b32 v9, 64, v8
    v_add3_u32 v3, s36, v6, 14
    v_bfe_u32 v4, v3, 1, 3
    v_xor_b32 v4, v4, v7
    v_lshlrev_b32 v3, 7, v3
    v_lshl_add_u32 v10, v4, 4, v3
    v_xor_b32 v11, 64, v10
    v_lshrrev_b32 v3, 2, v6
    v_lshl_add_u32 v3, v7, 3, v3
    v_lshlrev_b32 v3, 7, v3
    v_and_b32 v4, 3, v2
    v_lshl_add_u32 v5, v4, 3, v3
    v_lshlrev_b32 v3, 2, v6
    v_lshl_add_u32 v3, v7, 10, v3
    v_add_u32 v3, s3, v3
    v_add_u32 v4, 3584, v3
    v_lshlrev_b32 v6, 4, v2
    v_add_u32 v1, s3, v6
    s_lshl_b32 s36, s36, 8
    s_add_u32 s36, s36, s16
    s_add_u32 s36, s36, 256
    s_add_u32 s38, s36, 4096
    s_mov_b32 s66, 1069066811
    s_mov_b32 s67, 0x80000000
    s_mov_b32 s68, 0x07060100
    s_mov_b32 s69, 0x07060302
    v_mov_b32 v7, 0x00800000
    s_add_u32 m0, s35, 75264
    s_setprio 3
    s_cmp_ge_u32 s18, 224
    s_waitcnt vmcnt(0)
    s_barrier
    s_cbranch_scc1 L1_hnog
    ds_read_b128 v[72:75], v8 offset:23040
    ds_read_b128 v[76:79], v9 offset:23040
    ds_read_b128 v[80:83], v10 offset:23040
    ds_read_b128 v[84:87], v11 offset:23040
    ds_read_b64_tr_b16 v[88:89], v5 offset:6656
    ds_read_b64_tr_b16 v[90:91], v5 offset:7168
    ds_read_b64_tr_b16 v[92:93], v5 offset:10752
    ds_read_b64_tr_b16 v[94:95], v5 offset:11264
    ds_read_b64_tr_b16 v[96:97], v5 offset:14848
    ds_read_b64_tr_b16 v[98:99], v5 offset:15360
    ds_read_b64_tr_b16 v[100:101], v5 offset:18944
    ds_read_b64_tr_b16 v[102:103], v5 offset:19456
    ds_read_b64_tr_b16 v[104:105], v5 offset:6720
    ds_read_b64_tr_b16 v[106:107], v5 offset:7232
    ds_read_b64_tr_b16 v[108:109], v5 offset:10816
    ds_read_b64_tr_b16 v[110:111], v5 offset:11328
    s_waitcnt lgkmcnt(8)
    v_mfma_f32_16x16x32_bf16 v[8:11], v[72:75], v[88:91], 0
    v_mfma_f32_16x16x32_bf16 v[40:43], v[80:83], v[88:91], 0
    v_mfma_f32_16x16x32_bf16 v[8:11], v[76:79], v[92:95], v[8:11]
    v_mfma_f32_16x16x32_bf16 v[40:43], v[84:87], v[92:95], v[40:43]
    ds_read_b64_tr_b16 v[112:113], v5 offset:14912
    ds_read_b64_tr_b16 v[114:115], v5 offset:15424
    ds_read_b64_tr_b16 v[116:117], v5 offset:19008
    ds_read_b64_tr_b16 v[118:119], v5 offset:19520
    s_waitcnt lgkmcnt(8)
    v_mfma_f32_16x16x32_bf16 v[24:27], v[72:75], v[96:99], 0
    v_mfma_f32_16x16x32_bf16 v[56:59], v[80:83], v[96:99], 0
    v_mfma_f32_16x16x32_bf16 v[24:27], v[76:79], v[100:103], v[24:27]
    v_mfma_f32_16x16x32_bf16 v[56:59], v[84:87], v[100:103], v[56:59]
    ds_read_b64_tr_b16 v[88:89], v5 offset:6688
    ds_read_b64_tr_b16 v[90:91], v5 offset:7200
    ds_read_b64_tr_b16 v[92:93], v5 offset:10784
    ds_read_b64_tr_b16 v[94:95], v5 offset:11296
    s_waitcnt lgkmcnt(8)
    v_mfma_f32_16x16x32_bf16 v[16:19], v[72:75], v[104:107], 0
    v_mfma_f32_16x16x32_bf16 v[48:51], v[80:83], v[104:107], 0
    v_mfma_f32_16x16x32_bf16 v[16:19], v[76:79], v[108:111], v[16:19]
    v_mfma_f32_16x16x32_bf16 v[48:51], v[84:87], v[108:111], v[48:51]
    ds_read_b64_tr_b16 v[96:97], v5 offset:14880
    ds_read_b64_tr_b16 v[98:99], v5 offset:15392
    ds_read_b64_tr_b16 v[100:101], v5 offset:18976
    ds_read_b64_tr_b16 v[102:103], v5 offset:19488
    s_waitcnt lgkmcnt(8)
    v_mfma_f32_16x16x32_bf16 v[32:35], v[72:75], v[112:115], 0
    v_mfma_f32_16x16x32_bf16 v[64:67], v[80:83], v[112:115], 0
    v_mfma_f32_16x16x32_bf16 v[32:35], v[76:79], v[116:119], v[32:35]
    v_mfma_f32_16x16x32_bf16 v[64:67], v[84:87], v[116:119], v[64:67]
    ds_read_b64_tr_b16 v[104:105], v5 offset:6752
    ds_read_b64_tr_b16 v[106:107], v5 offset:7264
    ds_read_b64_tr_b16 v[108:109], v5 offset:10848
    ds_read_b64_tr_b16 v[110:111], v5 offset:11360
    s_waitcnt lgkmcnt(8)
    v_mfma_f32_16x16x32_bf16 v[12:15], v[72:75], v[88:91], 0
    v_mfma_f32_16x16x32_bf16 v[44:47], v[80:83], v[88:91], 0
    v_mfma_f32_16x16x32_bf16 v[12:15], v[76:79], v[92:95], v[12:15]
    v_mfma_f32_16x16x32_bf16 v[44:47], v[84:87], v[92:95], v[44:47]
    ds_read_b64_tr_b16 v[112:113], v5 offset:14944
    ds_read_b64_tr_b16 v[114:115], v5 offset:15456
    ds_read_b64_tr_b16 v[116:117], v5 offset:19040
    ds_read_b64_tr_b16 v[118:119], v5 offset:19552
    s_waitcnt lgkmcnt(8)
    v_mfma_f32_16x16x32_bf16 v[28:31], v[72:75], v[96:99], 0
    v_mfma_f32_16x16x32_bf16 v[60:63], v[80:83], v[96:99], 0
    v_mfma_f32_16x16x32_bf16 v[28:31], v[76:79], v[100:103], v[28:31]
    v_mfma_f32_16x16x32_bf16 v[60:63], v[84:87], v[100:103], v[60:63]
    s_waitcnt lgkmcnt(4)
    v_mfma_f32_16x16x32_bf16 v[20:23], v[72:75], v[104:107], 0
    v_mfma_f32_16x16x32_bf16 v[52:55], v[80:83], v[104:107], 0
    v_mfma_f32_16x16x32_bf16 v[20:23], v[76:79], v[108:111], v[20:23]
    v_mfma_f32_16x16x32_bf16 v[52:55], v[84:87], v[108:111], v[52:55]
    s_waitcnt lgkmcnt(0)
    v_mfma_f32_16x16x32_bf16 v[36:39], v[72:75], v[112:115], 0
    v_mfma_f32_16x16x32_bf16 v[68:71], v[80:83], v[112:115], 0
    v_mfma_f32_16x16x32_bf16 v[36:39], v[76:79], v[116:119], v[36:39]
    v_mfma_f32_16x16x32_bf16 v[68:71], v[84:87], v[116:119], v[68:71]
    v_fma_f32 v88, |v8|, s66, v7
    v_fma_f32 v89, |v9|, s66, v7
    v_fma_f32 v90, |v10|, s66, v7
    v_fma_f32 v91, |v11|, s66, v7
    v_fma_f32 v92, |v12|, s66, v7
    v_fma_f32 v93, |v13|, s66, v7
    v_fma_f32 v94, |v14|, s66, v7
    v_fma_f32 v95, |v15|, s66, v7
    v_cvt_pk_bf16_f32 v24, v24, -v24
    v_cvt_pk_bf16_f32 v25, v25, -v25
    v_cvt_pk_bf16_f32 v26, v26, -v26
    v_cvt_pk_bf16_f32 v27, v27, -v27
    v_cvt_pk_bf16_f32 v28, v28, -v28
    v_cvt_pk_bf16_f32 v29, v29, -v29
    v_cvt_pk_bf16_f32 v30, v30, -v30
    v_cvt_pk_bf16_f32 v31, v31, -v31
    v_sub_u32_sdwa v88, v88, sext(v24) dst_sel:DWORD dst_unused:UNUSED_PAD src0_sel:DWORD src1_sel:WORD_1
    v_sub_u32_sdwa v89, v89, sext(v25) dst_sel:DWORD dst_unused:UNUSED_PAD src0_sel:DWORD src1_sel:WORD_1
    v_sub_u32_sdwa v90, v90, sext(v26) dst_sel:DWORD dst_unused:UNUSED_PAD src0_sel:DWORD src1_sel:WORD_1
    v_sub_u32_sdwa v91, v91, sext(v27) dst_sel:DWORD dst_unused:UNUSED_PAD src0_sel:DWORD src1_sel:WORD_1
    v_sub_u32_sdwa v92, v92, sext(v28) dst_sel:DWORD dst_unused:UNUSED_PAD src0_sel:DWORD src1_sel:WORD_1
    v_sub_u32_sdwa v93, v93, sext(v29) dst_sel:DWORD dst_unused:UNUSED_PAD src0_sel:DWORD src1_sel:WORD_1
    v_sub_u32_sdwa v94, v94, sext(v30) dst_sel:DWORD dst_unused:UNUSED_PAD src0_sel:DWORD src1_sel:WORD_1
    v_sub_u32_sdwa v95, v95, sext(v31) dst_sel:DWORD dst_unused:UNUSED_PAD src0_sel:DWORD src1_sel:WORD_1
    v_perm_b32 v88, v88, v24, s68
    v_perm_b32 v89, v89, v25, s68
    v_perm_b32 v90, v90, v26, s68
    v_perm_b32 v91, v91, v27, s68
    v_perm_b32 v92, v92, v28, s68
    v_perm_b32 v93, v93, v29, s68
    v_perm_b32 v94, v94, v30, s68
    v_perm_b32 v95, v95, v31, s68
    v_bitop3_b32 v104, v88, v8, s67 bitop3:0xf8
    v_bitop3_b32 v105, v89, v9, s67 bitop3:0xf8
    v_bitop3_b32 v106, v90, v10, s67 bitop3:0xf8
    v_bitop3_b32 v107, v91, v11, s67 bitop3:0xf8
    v_bitop3_b32 v108, v92, v12, s67 bitop3:0xf8
    v_bitop3_b32 v109, v93, v13, s67 bitop3:0xf8
    v_bitop3_b32 v110, v94, v14, s67 bitop3:0xf8
    v_bitop3_b32 v111, v95, v15, s67 bitop3:0xf8
    v_bitop3_b32 v8, v88, v8, s67 bitop3:0xf2
    v_bitop3_b32 v9, v89, v9, s67 bitop3:0xf2
    v_bitop3_b32 v10, v90, v10, s67 bitop3:0xf2
    v_bitop3_b32 v11, v91, v11, s67 bitop3:0xf2
    v_bitop3_b32 v12, v92, v12, s67 bitop3:0xf2
    v_bitop3_b32 v13, v93, v13, s67 bitop3:0xf2
    v_bitop3_b32 v14, v94, v14, s67 bitop3:0xf2
    v_bitop3_b32 v15, v95, v15, s67 bitop3:0xf2
    v_add_f32 v112, |v32|, v7
    v_add_f32 v113, |v33|, v7
    v_add_f32 v114, |v34|, v7
    v_add_f32 v115, |v35|, v7
    v_add_f32 v116, |v36|, v7
    v_add_f32 v117, |v37|, v7
    v_add_f32 v118, |v38|, v7
    v_add_f32 v119, |v39|, v7
    v_fma_f32 v96, |v16|, s66, v7
    v_fma_f32 v97, |v17|, s66, v7
    v_fma_f32 v98, |v18|, s66, v7
    v_fma_f32 v99, |v19|, s66, v7
    v_fma_f32 v100, |v20|, s66, v7
    v_fma_f32 v101, |v21|, s66, v7
    v_fma_f32 v102, |v22|, s66, v7
    v_fma_f32 v103, |v23|, s66, v7
    v_sub_u32_sdwa v112, v112, sext(v104) dst_sel:DWORD dst_unused:UNUSED_PAD src0_sel:DWORD src1_sel:WORD_1
    v_sub_u32_sdwa v113, v113, sext(v105) dst_sel:DWORD dst_unused:UNUSED_PAD src0_sel:DWORD src1_sel:WORD_1
    v_sub_u32_sdwa v114, v114, sext(v106) dst_sel:DWORD dst_unused:UNUSED_PAD src0_sel:DWORD src1_sel:WORD_1
    v_sub_u32_sdwa v115, v115, sext(v107) dst_sel:DWORD dst_unused:UNUSED_PAD src0_sel:DWORD src1_sel:WORD_1
    v_sub_u32_sdwa v116, v116, sext(v108) dst_sel:DWORD dst_unused:UNUSED_PAD src0_sel:DWORD src1_sel:WORD_1
    v_sub_u32_sdwa v117, v117, sext(v109) dst_sel:DWORD dst_unused:UNUSED_PAD src0_sel:DWORD src1_sel:WORD_1
    v_sub_u32_sdwa v118, v118, sext(v110) dst_sel:DWORD dst_unused:UNUSED_PAD src0_sel:DWORD src1_sel:WORD_1
    v_sub_u32_sdwa v119, v119, sext(v111) dst_sel:DWORD dst_unused:UNUSED_PAD src0_sel:DWORD src1_sel:WORD_1
    v_bitop3_b32 v104, v112, v32, s67 bitop3:0xf2
    v_bitop3_b32 v105, v113, v33, s67 bitop3:0xf2
    v_bitop3_b32 v106, v114, v34, s67 bitop3:0xf2
    v_bitop3_b32 v107, v115, v35, s67 bitop3:0xf2
    v_bitop3_b32 v108, v116, v36, s67 bitop3:0xf2
    v_bitop3_b32 v109, v117, v37, s67 bitop3:0xf2
    v_bitop3_b32 v110, v118, v38, s67 bitop3:0xf2
    v_bitop3_b32 v111, v119, v39, s67 bitop3:0xf2
    v_bitop3_b32 v112, v112, v32, s67 bitop3:0xf8
    v_bitop3_b32 v113, v113, v33, s67 bitop3:0xf8
    v_bitop3_b32 v114, v114, v34, s67 bitop3:0xf8
    v_bitop3_b32 v115, v115, v35, s67 bitop3:0xf8
    v_bitop3_b32 v116, v116, v36, s67 bitop3:0xf8
    v_bitop3_b32 v117, v117, v37, s67 bitop3:0xf8
    v_bitop3_b32 v118, v118, v38, s67 bitop3:0xf8
    v_bitop3_b32 v119, v119, v39, s67 bitop3:0xf8
    v_sub_u32_sdwa v96, v96, sext(v104) dst_sel:DWORD dst_unused:UNUSED_PAD src0_sel:DWORD src1_sel:WORD_1
    v_sub_u32_sdwa v97, v97, sext(v105) dst_sel:DWORD dst_unused:UNUSED_PAD src0_sel:DWORD src1_sel:WORD_1
    v_sub_u32_sdwa v98, v98, sext(v106) dst_sel:DWORD dst_unused:UNUSED_PAD src0_sel:DWORD src1_sel:WORD_1
    v_sub_u32_sdwa v99, v99, sext(v107) dst_sel:DWORD dst_unused:UNUSED_PAD src0_sel:DWORD src1_sel:WORD_1
    v_sub_u32_sdwa v100, v100, sext(v108) dst_sel:DWORD dst_unused:UNUSED_PAD src0_sel:DWORD src1_sel:WORD_1
    v_sub_u32_sdwa v101, v101, sext(v109) dst_sel:DWORD dst_unused:UNUSED_PAD src0_sel:DWORD src1_sel:WORD_1
    v_sub_u32_sdwa v102, v102, sext(v110) dst_sel:DWORD dst_unused:UNUSED_PAD src0_sel:DWORD src1_sel:WORD_1
    v_sub_u32_sdwa v103, v103, sext(v111) dst_sel:DWORD dst_unused:UNUSED_PAD src0_sel:DWORD src1_sel:WORD_1
    v_perm_b32 v96, v96, v112, s69
    v_perm_b32 v97, v97, v113, s69
    v_perm_b32 v98, v98, v114, s69
    v_perm_b32 v99, v99, v115, s69
    v_perm_b32 v100, v100, v116, s69
    v_perm_b32 v101, v101, v117, s69
    v_perm_b32 v102, v102, v118, s69
    v_perm_b32 v103, v103, v119, s69
    v_bitop3_b32 v16, v96, v16, s67 bitop3:0xf2
    ds_write2_b32 v3, v8, v16 offset0:0 offset1:32
    v_bitop3_b32 v17, v97, v17, s67 bitop3:0xf2
    ds_write2_b32 v3, v9, v17 offset0:64 offset1:96
    v_bitop3_b32 v18, v98, v18, s67 bitop3:0xf2
    ds_write2_b32 v3, v10, v18 offset0:128 offset1:160
    v_bitop3_b32 v19, v99, v19, s67 bitop3:0xf2
    ds_write2_b32 v3, v11, v19 offset0:192 offset1:224
    v_bitop3_b32 v20, v100, v20, s67 bitop3:0xf2
    ds_write2_b32 v3, v12, v20 offset0:16 offset1:48
    v_bitop3_b32 v21, v101, v21, s67 bitop3:0xf2
    ds_write2_b32 v3, v13, v21 offset0:80 offset1:112
    v_bitop3_b32 v22, v102, v22, s67 bitop3:0xf2
    ds_write2_b32 v3, v14, v22 offset0:144 offset1:176
    v_bitop3_b32 v23, v103, v23, s67 bitop3:0xf2
    ds_write2_b32 v3, v15, v23 offset0:208 offset1:240
    v_fma_f32 v88, |v40|, s66, v7
    v_fma_f32 v89, |v41|, s66, v7
    v_fma_f32 v90, |v42|, s66, v7
    v_fma_f32 v91, |v43|, s66, v7
    v_fma_f32 v92, |v44|, s66, v7
    v_fma_f32 v93, |v45|, s66, v7
    v_fma_f32 v94, |v46|, s66, v7
    v_fma_f32 v95, |v47|, s66, v7
    v_cvt_pk_bf16_f32 v56, v56, -v56
    v_cvt_pk_bf16_f32 v57, v57, -v57
    v_cvt_pk_bf16_f32 v58, v58, -v58
    v_cvt_pk_bf16_f32 v59, v59, -v59
    v_cvt_pk_bf16_f32 v60, v60, -v60
    v_cvt_pk_bf16_f32 v61, v61, -v61
    v_cvt_pk_bf16_f32 v62, v62, -v62
    v_cvt_pk_bf16_f32 v63, v63, -v63
    v_sub_u32_sdwa v88, v88, sext(v56) dst_sel:DWORD dst_unused:UNUSED_PAD src0_sel:DWORD src1_sel:WORD_1
    v_sub_u32_sdwa v89, v89, sext(v57) dst_sel:DWORD dst_unused:UNUSED_PAD src0_sel:DWORD src1_sel:WORD_1
    v_sub_u32_sdwa v90, v90, sext(v58) dst_sel:DWORD dst_unused:UNUSED_PAD src0_sel:DWORD src1_sel:WORD_1
    v_sub_u32_sdwa v91, v91, sext(v59) dst_sel:DWORD dst_unused:UNUSED_PAD src0_sel:DWORD src1_sel:WORD_1
    v_sub_u32_sdwa v92, v92, sext(v60) dst_sel:DWORD dst_unused:UNUSED_PAD src0_sel:DWORD src1_sel:WORD_1
    v_sub_u32_sdwa v93, v93, sext(v61) dst_sel:DWORD dst_unused:UNUSED_PAD src0_sel:DWORD src1_sel:WORD_1
    v_sub_u32_sdwa v94, v94, sext(v62) dst_sel:DWORD dst_unused:UNUSED_PAD src0_sel:DWORD src1_sel:WORD_1
    v_sub_u32_sdwa v95, v95, sext(v63) dst_sel:DWORD dst_unused:UNUSED_PAD src0_sel:DWORD src1_sel:WORD_1
    v_perm_b32 v88, v88, v56, s68
    v_perm_b32 v89, v89, v57, s68
    v_perm_b32 v90, v90, v58, s68
    v_perm_b32 v91, v91, v59, s68
    v_perm_b32 v92, v92, v60, s68
    v_perm_b32 v93, v93, v61, s68
    v_perm_b32 v94, v94, v62, s68
    v_perm_b32 v95, v95, v63, s68
    v_bitop3_b32 v104, v88, v40, s67 bitop3:0xf8
    v_bitop3_b32 v105, v89, v41, s67 bitop3:0xf8
    v_bitop3_b32 v106, v90, v42, s67 bitop3:0xf8
    v_bitop3_b32 v107, v91, v43, s67 bitop3:0xf8
    v_bitop3_b32 v108, v92, v44, s67 bitop3:0xf8
    v_bitop3_b32 v109, v93, v45, s67 bitop3:0xf8
    v_bitop3_b32 v110, v94, v46, s67 bitop3:0xf8
    v_bitop3_b32 v111, v95, v47, s67 bitop3:0xf8
    v_bitop3_b32 v40, v88, v40, s67 bitop3:0xf2
    v_bitop3_b32 v41, v89, v41, s67 bitop3:0xf2
    v_bitop3_b32 v42, v90, v42, s67 bitop3:0xf2
    v_bitop3_b32 v43, v91, v43, s67 bitop3:0xf2
    v_bitop3_b32 v44, v92, v44, s67 bitop3:0xf2
    v_bitop3_b32 v45, v93, v45, s67 bitop3:0xf2
    v_bitop3_b32 v46, v94, v46, s67 bitop3:0xf2
    v_bitop3_b32 v47, v95, v47, s67 bitop3:0xf2
    v_add_f32 v112, |v64|, v7
    v_add_f32 v113, |v65|, v7
    v_add_f32 v114, |v66|, v7
    v_add_f32 v115, |v67|, v7
    v_add_f32 v116, |v68|, v7
    v_add_f32 v117, |v69|, v7
    v_add_f32 v118, |v70|, v7
    v_add_f32 v119, |v71|, v7
    v_fma_f32 v96, |v48|, s66, v7
    v_fma_f32 v97, |v49|, s66, v7
    v_fma_f32 v98, |v50|, s66, v7
    v_fma_f32 v99, |v51|, s66, v7
    v_fma_f32 v100, |v52|, s66, v7
    v_fma_f32 v101, |v53|, s66, v7
    v_fma_f32 v102, |v54|, s66, v7
    v_fma_f32 v103, |v55|, s66, v7
    v_sub_u32_sdwa v112, v112, sext(v104) dst_sel:DWORD dst_unused:UNUSED_PAD src0_sel:DWORD src1_sel:WORD_1
    v_sub_u32_sdwa v113, v113, sext(v105) dst_sel:DWORD dst_unused:UNUSED_PAD src0_sel:DWORD src1_sel:WORD_1
    v_sub_u32_sdwa v114, v114, sext(v106) dst_sel:DWORD dst_unused:UNUSED_PAD src0_sel:DWORD src1_sel:WORD_1
    v_sub_u32_sdwa v115, v115, sext(v107) dst_sel:DWORD dst_unused:UNUSED_PAD src0_sel:DWORD src1_sel:WORD_1
    v_sub_u32_sdwa v116, v116, sext(v108) dst_sel:DWORD dst_unused:UNUSED_PAD src0_sel:DWORD src1_sel:WORD_1
    v_sub_u32_sdwa v117, v117, sext(v109) dst_sel:DWORD dst_unused:UNUSED_PAD src0_sel:DWORD src1_sel:WORD_1
    v_sub_u32_sdwa v118, v118, sext(v110) dst_sel:DWORD dst_unused:UNUSED_PAD src0_sel:DWORD src1_sel:WORD_1
    v_sub_u32_sdwa v119, v119, sext(v111) dst_sel:DWORD dst_unused:UNUSED_PAD src0_sel:DWORD src1_sel:WORD_1
    v_bitop3_b32 v104, v112, v64, s67 bitop3:0xf2
    v_bitop3_b32 v105, v113, v65, s67 bitop3:0xf2
    v_bitop3_b32 v106, v114, v66, s67 bitop3:0xf2
    v_bitop3_b32 v107, v115, v67, s67 bitop3:0xf2
    v_bitop3_b32 v108, v116, v68, s67 bitop3:0xf2
    v_bitop3_b32 v109, v117, v69, s67 bitop3:0xf2
    v_bitop3_b32 v110, v118, v70, s67 bitop3:0xf2
    v_bitop3_b32 v111, v119, v71, s67 bitop3:0xf2
    v_bitop3_b32 v112, v112, v64, s67 bitop3:0xf8
    v_bitop3_b32 v113, v113, v65, s67 bitop3:0xf8
    v_bitop3_b32 v114, v114, v66, s67 bitop3:0xf8
    v_bitop3_b32 v115, v115, v67, s67 bitop3:0xf8
    v_bitop3_b32 v116, v116, v68, s67 bitop3:0xf8
    v_bitop3_b32 v117, v117, v69, s67 bitop3:0xf8
    v_bitop3_b32 v118, v118, v70, s67 bitop3:0xf8
    v_bitop3_b32 v119, v119, v71, s67 bitop3:0xf8
    v_sub_u32_sdwa v96, v96, sext(v104) dst_sel:DWORD dst_unused:UNUSED_PAD src0_sel:DWORD src1_sel:WORD_1
    v_sub_u32_sdwa v97, v97, sext(v105) dst_sel:DWORD dst_unused:UNUSED_PAD src0_sel:DWORD src1_sel:WORD_1
    v_sub_u32_sdwa v98, v98, sext(v106) dst_sel:DWORD dst_unused:UNUSED_PAD src0_sel:DWORD src1_sel:WORD_1
    v_sub_u32_sdwa v99, v99, sext(v107) dst_sel:DWORD dst_unused:UNUSED_PAD src0_sel:DWORD src1_sel:WORD_1
    v_sub_u32_sdwa v100, v100, sext(v108) dst_sel:DWORD dst_unused:UNUSED_PAD src0_sel:DWORD src1_sel:WORD_1
    v_sub_u32_sdwa v101, v101, sext(v109) dst_sel:DWORD dst_unused:UNUSED_PAD src0_sel:DWORD src1_sel:WORD_1
    v_sub_u32_sdwa v102, v102, sext(v110) dst_sel:DWORD dst_unused:UNUSED_PAD src0_sel:DWORD src1_sel:WORD_1
    v_sub_u32_sdwa v103, v103, sext(v111) dst_sel:DWORD dst_unused:UNUSED_PAD src0_sel:DWORD src1_sel:WORD_1
    v_perm_b32 v96, v96, v112, s69
    v_perm_b32 v97, v97, v113, s69
    v_perm_b32 v98, v98, v114, s69
    v_perm_b32 v99, v99, v115, s69
    v_perm_b32 v100, v100, v116, s69
    v_perm_b32 v101, v101, v117, s69
    v_perm_b32 v102, v102, v118, s69
    v_perm_b32 v103, v103, v119, s69
    v_bitop3_b32 v48, v96, v48, s67 bitop3:0xf2
    ds_write2_b32 v4, v40, v48 offset0:0 offset1:32
    v_bitop3_b32 v49, v97, v49, s67 bitop3:0xf2
    ds_write2_b32 v4, v41, v49 offset0:64 offset1:96
    v_bitop3_b32 v50, v98, v50, s67 bitop3:0xf2
    ds_write2_b32 v4, v42, v50 offset0:128 offset1:160
    v_bitop3_b32 v51, v99, v51, s67 bitop3:0xf2
    ds_write2_b32 v4, v43, v51 offset0:192 offset1:224
    v_bitop3_b32 v52, v100, v52, s67 bitop3:0xf2
    ds_write2_b32 v4, v44, v52 offset0:16 offset1:48
    v_bitop3_b32 v53, v101, v53, s67 bitop3:0xf2
    ds_write2_b32 v4, v45, v53 offset0:80 offset1:112
    v_bitop3_b32 v54, v102, v54, s67 bitop3:0xf2
    ds_write2_b32 v4, v46, v54 offset0:144 offset1:176
    v_bitop3_b32 v55, v103, v55, s67 bitop3:0xf2
    ds_write2_b32 v4, v47, v55 offset0:208 offset1:240
    s_waitcnt lgkmcnt(0)
    ds_read_b128 v[72:75], v1 offset:0
    ds_read_b128 v[76:79], v1 offset:1024
    ds_read_b128 v[80:83], v1 offset:2048
    ds_read_b128 v[84:87], v1 offset:3072
    ds_read_b128 v[88:91], v1 offset:4096
    ds_read_b128 v[92:95], v1 offset:5120
    ds_read_b128 v[96:99], v1 offset:6144
    s_waitcnt lgkmcnt(6)
    buffer_store_dwordx4 v[72:75], v6, s[12:15], s36 offen offset:0 sc1
    s_waitcnt lgkmcnt(5)
    buffer_store_dwordx4 v[76:79], v6, s[12:15], s36 offen offset:1024 sc1
    s_waitcnt lgkmcnt(4)
    buffer_store_dwordx4 v[80:83], v6, s[12:15], s36 offen offset:2048 sc1
    s_waitcnt lgkmcnt(3)
    buffer_store_dwordx4 v[84:87], v6, s[12:15], s36 offen offset:3072 sc1
    s_waitcnt lgkmcnt(2)
    buffer_store_dwordx4 v[88:91], v6, s[12:15], s38 offen offset:0 sc1
    s_waitcnt lgkmcnt(1)
    buffer_store_dwordx4 v[92:95], v6, s[12:15], s38 offen offset:1024 sc1
    s_waitcnt lgkmcnt(0)
    buffer_store_dwordx4 v[96:99], v6, s[12:15], s38 offen offset:2048 sc1
    s_cmp_lg_u32 s36, 256
    s_cbranch_scc1 L1_nozr
    v_mov_b32 v3, 0
    v_lshlrev_b32 v4, 2, v2
    buffer_store_dword v3, v4, s[12:15], 0 offen sc1
L1_nozr:
L1_hnog:
    v_mov_b32 v40, v6
    v_add_u32 v41, 4096, v6
    v_lshlrev_b32 v5, 1, v2
    v_add_u32 v5, 16384, v5
    v_mov_b32 v1, 0
    global_load_dwordx2 v[12:13], v1, s[88:89] sc1
    global_load_ushort v16, v5, s[84:85] offset:0
    global_load_ushort v17, v5, s[84:85] offset:128
    global_load_ushort v18, v5, s[84:85] offset:256
    global_load_ushort v19, v5, s[84:85] offset:384
    global_load_lds_dwordx4 v40, s[26:27] offset:0
    global_load_lds_dwordx4 v40, s[26:27] offset:1024
    global_load_lds_dwordx4 v40, s[26:27] offset:2048
    global_load_lds_dwordx4 v40, s[26:27] offset:3072
    s_add_u32 m0, m0, 4096
    s_nop 0
    global_load_lds_dwordx4 v41, s[26:27] offset:0
    global_load_lds_dwordx4 v41, s[26:27] offset:1024
    global_load_lds_dwordx4 v41, s[26:27] offset:2048
    global_load_lds_dwordx4 v41, s[26:27] offset:3072
    s_cmp_ge_u32 s18, 224
    s_barrier
    s_setprio 0
    s_nop 0
    v_and_b32 v98, 63, v0
    v_mov_b32 v3, 0
    s_cmp_eq_u32 s28, 15
    s_cbranch_scc1 L1_h15
    ds_read_b128 v[32:35], v40 offset:512
    s_waitcnt lgkmcnt(0)
    v_add_u32 v41, v32, v33
    v_add_u32 v42, v41, v34
    v_add_u32 v43, v42, v35
    v_add_u32 v44, v42, v35
    s_nop 1
    v_add_u32_dpp v44, v44, v44 row_shr:1 row_mask:0xf bank_mask:0xf bound_ctrl:1
    s_nop 1
    v_add_u32_dpp v44, v44, v44 row_shr:2 row_mask:0xf bank_mask:0xf bound_ctrl:1
    s_nop 1
    v_add_u32_dpp v44, v44, v44 row_shr:4 row_mask:0xf bank_mask:0xf bound_ctrl:1
    s_nop 1
    v_add_u32_dpp v44, v44, v44 row_shr:8 row_mask:0xf bank_mask:0xf bound_ctrl:1
    s_nop 1
    v_add_u32_dpp v44, v44, v44 row_bcast:15 row_mask:0xa bank_mask:0xf
    s_nop 1
    v_add_u32_dpp v44, v44, v44 row_bcast:31 row_mask:0xc bank_mask:0xf
    v_sub_u32 v36, v44, v43
    v_add_u32 v37, v36, v32
    v_add_u32 v38, v36, v41
    v_add_u32 v39, v36, v42
    v_lshl_or_b32 v36, v32, 12, v36
    v_lshl_or_b32 v37, v33, 12, v37
    v_lshl_or_b32 v38, v34, 12, v38
    v_lshl_or_b32 v39, v35, 12, v39
    ds_write_b128 v40, v[36:39] offset:3072
    v_lshlrev_b32 v2, 3, v98
    s_waitcnt lgkmcnt(0)
    ds_read_b32 v4, v2 offset:3072
    ds_read_b32 v6, v2 offset:3076
    ds_read_b32 v8, v2 offset:3584
    ds_read_b32 v10, v2 offset:3588
    s_mov_b32 s41, 40000
    s_mov_b32 s3, 0x9e3779b1
L1_npoll:
    s_waitcnt vmcnt(0)
    v_cmp_ne_u32 vcc, 0, v13
    s_cbranch_vccnz L1_nok
    global_load_dwordx2 v[12:13], v3, s[88:89] sc1
    s_sub_u32 s41, s41, 1
    s_cbranch_scc0 L1_npoll
    s_waitcnt vmcnt(0)
L1_nok:
    ds_write_b32 v3, v12 offset:272
    v_mul_lo_u32 v13, v12, s3
    v_and_b32 v13, 0xff000000, v13
    v_mov_b32 v5, v12
    v_mov_b32 v7, v12
    v_mov_b32 v9, v12
    v_mov_b32 v11, v12
    s_waitcnt lgkmcnt(0)
    v_or_b32 v4, v13, v4
    v_or_b32 v6, v13, v6
    v_or_b32 v8, v13, v8
    v_or_b32 v10, v13, v10
    s_setprio 3
    s_branch L1_hend
L1_h15:
    s_mov_b32 s36, 3216550459
    s_waitcnt vmcnt(0)
    v_lshlrev_b32 v16, 16, v16
    v_mul_f32 v16, s36, v16
    v_lshlrev_b32 v17, 16, v17
    v_mul_f32 v17, s36, v17
    v_lshlrev_b32 v18, 16, v18
    v_mul_f32 v18, s36, v18
    v_lshlrev_b32 v19, 16, v19
    v_mul_f32 v19, s36, v19
    v_cvt_pk_bf16_f32 v8, v16, v17
    v_cvt_pk_bf16_f32 v9, v18, v19
    v_lshlrev_b32 v2, 3, v98
    ds_write_b64 v2, v[8:9] offset:2560
L1_hend:
    s_branch L1_join
L2_gemm:
    v_lshrrev_b32 v3, 5, v98
    v_lshlrev_b32 v3, 10, v3
    v_bfe_u32 v100, v98, 4, 1
    v_lshl_add_u32 v3, v100, 5, v3
    v_bfe_u32 v100, v98, 2, 2
    v_lshl_add_u32 v3, v100, 7, v3
    v_and_b32 v100, 3, v98
    v_lshl_add_u32 v3, v100, 3, v3
    s_bfe_u32 s38, s28, 0x10001
    s_bfe_u32 s39, s28, 0x10002
    s_lshl_b32 s3, s39, 7
    s_add_u32 s3, s3, s38
    s_lshl_b32 s3, s3, 6
    s_add_u32 s3, s3, 75264
    v_add_u32 v3, s3, v3
    ds_read_b64_tr_b16 v[68:69], v3 offset:0
    ds_read_b64_tr_b16 v[70:71], v3 offset:512
    ds_read_b64_tr_b16 v[72:73], v3 offset:2048
    ds_read_b64_tr_b16 v[74:75], v3 offset:2560
    ds_read_b64_tr_b16 v[76:77], v3 offset:4096
    ds_read_b64_tr_b16 v[78:79], v3 offset:4608
    ds_read_b64_tr_b16 v[80:81], v3 offset:6144
    ds_read_b64_tr_b16 v[82:83], v3 offset:6656
    s_and_b32 s3, s28, 1
    s_mul_i32 s3, s3, 25
    v_and_b32 v1, 31, v98
    v_add_u32 v1, s3, v1
    v_lshrrev_b32 v2, 5, v98
    v_bfe_u32 v100, v1, 1, 3
    v_xor_b32 v100, v100, v2
    v_lshlrev_b32 v1, 7, v1
    v_add_u32 v1, 91648, v1
    v_lshl_add_u32 v1, v100, 4, v1
    v_xor_b32 v101, 0, v1
    ds_read_b128 v[52:55], v101
    v_xor_b32 v101, 32, v1
    ds_read_b128 v[56:59], v101
    v_xor_b32 v101, 64, v1
    ds_read_b128 v[60:63], v101
    v_xor_b32 v101, 96, v1
    ds_read_b128 v[64:67], v101
    s_waitcnt lgkmcnt(3)
    v_mfma_f32_32x32x16_bf16 v[104:119], v[52:55], v[68:71], 0
    s_waitcnt lgkmcnt(2)
    v_mfma_f32_32x32x16_bf16 v[104:119], v[56:59], v[72:75], v[104:119]
    s_waitcnt lgkmcnt(1)
    v_mfma_f32_32x32x16_bf16 v[104:119], v[60:63], v[76:79], v[104:119]
    s_waitcnt lgkmcnt(0)
    v_mfma_f32_32x32x16_bf16 v[104:119], v[64:67], v[80:83], v[104:119]
    s_mul_i32 s3, s3, 768
    s_add_u32 s3, s3, 99840
    v_mul_u32_u24 v3, 3072, v2
    v_add3_u32 v3, v3, v96, s3
    s_cmp_eq_u32 s39, 0
    s_cbranch_scc1 L2_pgemm
    s_lshl_b32 s38, s38, 8
    v_add_u32 v3, s38, v3
    s_nop 4
    v_cvt_f64_f32 v[52:53], v104
    v_cvt_f64_f32 v[54:55], v105
    v_cvt_f64_f32 v[56:57], v106
    v_cvt_f64_f32 v[58:59], v107
    v_cvt_f64_f32 v[60:61], v108
    v_cvt_f64_f32 v[62:63], v109
    v_cvt_f64_f32 v[64:65], v110
    v_cvt_f64_f32 v[66:67], v111
    v_cvt_f64_f32 v[68:69], v112
    v_cvt_f64_f32 v[70:71], v113
    v_cvt_f64_f32 v[72:73], v114
    v_cvt_f64_f32 v[74:75], v115
    v_cvt_f64_f32 v[76:77], v116
    ds_write_b64 v3, v[52:53] offset:0
    ds_write_b64 v3, v[54:55] offset:768
    ds_write_b64 v3, v[56:57] offset:1536
    ds_write_b64 v3, v[58:59] offset:2304
    ds_write_b64 v3, v[60:61] offset:6144
    ds_write_b64 v3, v[62:63] offset:6912
    ds_write_b64 v3, v[64:65] offset:7680
    ds_write_b64 v3, v[66:67] offset:8448
    ds_write_b64 v3, v[68:69] offset:12288
    ds_write_b64 v3, v[70:71] offset:13056
    ds_write_b64 v3, v[72:73] offset:13824
    ds_write_b64 v3, v[74:75] offset:14592
    s_mov_b32 exec_hi, 0
    ds_write_b64 v3, v[76:77] offset:18432
    s_mov_b64 exec, -1
    s_branch L2_gemmx
L2_pgemm:
    s_lshl_b32 s38, s38, 2
    v_add_u32 v3, s38, v3
    s_mov_b32 s3, 3216550459
    s_nop 3
    v_mul_f32 v104, s3, v104
    v_mul_f32 v105, s3, v105
    v_mul_f32 v106, s3, v106
    v_mul_f32 v107, s3, v107
    v_mul_f32 v108, s3, v108
    v_mul_f32 v109, s3, v109
    v_mul_f32 v110, s3, v110
    v_mul_f32 v111, s3, v111
    v_mul_f32 v112, s3, v112
    v_mul_f32 v113, s3, v113
    v_mul_f32 v114, s3, v114
    v_mul_f32 v115, s3, v115
    v_mul_f32 v116, s3, v116
    v_and_b32 v52, 0xffff0000, v104
    v_and_b32 v53, 0xffff0000, v105
    v_and_b32 v54, 0xffff0000, v106
    v_and_b32 v55, 0xffff0000, v107
    v_and_b32 v56, 0xffff0000, v108
    v_and_b32 v57, 0xffff0000, v109
    v_and_b32 v58, 0xffff0000, v110
    v_and_b32 v59, 0xffff0000, v111
    v_and_b32 v60, 0xffff0000, v112
    v_and_b32 v61, 0xffff0000, v113
    v_and_b32 v62, 0xffff0000, v114
    v_and_b32 v63, 0xffff0000, v115
    v_and_b32 v64, 0xffff0000, v116
    v_sub_f32 v104, v104, v52
    v_sub_f32 v105, v105, v53
    v_sub_f32 v106, v106, v54
    v_sub_f32 v107, v107, v55
    v_sub_f32 v108, v108, v56
    v_sub_f32 v109, v109, v57
    v_sub_f32 v110, v110, v58
    v_sub_f32 v111, v111, v59
    v_sub_f32 v112, v112, v60
    v_sub_f32 v113, v113, v61
    v_sub_f32 v114, v114, v62
    v_sub_f32 v115, v115, v63
    v_sub_f32 v116, v116, v64
    v_cvt_pk_bf16_f32 v104, v52, v104
    v_cvt_pk_bf16_f32 v105, v53, v105
    ds_write2st64_b32 v3, v104, v105 offset0:2 offset1:5
    v_cvt_pk_bf16_f32 v106, v54, v106
    v_cvt_pk_bf16_f32 v107, v55, v107
    ds_write2st64_b32 v3, v106, v107 offset0:8 offset1:11
    v_cvt_pk_bf16_f32 v108, v56, v108
    v_cvt_pk_bf16_f32 v109, v57, v109
    ds_write2st64_b32 v3, v108, v109 offset0:26 offset1:29
    v_cvt_pk_bf16_f32 v110, v58, v110
    v_cvt_pk_bf16_f32 v111, v59, v111
    ds_write2st64_b32 v3, v110, v111 offset0:32 offset1:35
    v_cvt_pk_bf16_f32 v112, v60, v112
    v_cvt_pk_bf16_f32 v113, v61, v113
    ds_write2st64_b32 v3, v112, v113 offset0:50 offset1:53
    v_cvt_pk_bf16_f32 v114, v62, v114
    v_cvt_pk_bf16_f32 v115, v63, v115
    ds_write2st64_b32 v3, v114, v115 offset0:56 offset1:59
    v_cvt_pk_bf16_f32 v116, v64, v116
    s_mov_b32 exec_hi, 0
    ds_write_b32 v3, v116 offset:18944
    s_mov_b64 exec, -1
    s_branch L2_gemmx
L2_gemmx:
    s_cmp_eq_u32 s32, 0
    s_cbranch_scc1 L2_gemmr
    s_branch L2_pass
L2_last:
L1_idle:
    s_mul_i32 s3, s2, 14336
    s_add_u32 s3, s3, 18874372
    s_lshl_b32 s35, s29, 3
    s_add_u32 s3, s3, s35
    s_cmp_lg_u32 s28, 0
    s_cbranch_scc1 L1_idle2
L1_idle1:
    buffer_load_dword v3, off, s[12:15], s3 sc1
    s_waitcnt vmcnt(0)
    v_cmp_eq_u32 vcc, s43, v3
    s_cbranch_vccnz L1_idle2
    s_sleep 2
    s_sub_u32 s41, s41, 1
    s_cbranch_scc0 L1_idle1
    s_mov_b32 s41, 0
L1_idle2:
    s_barrier
    s_branch L1_idler
L2_xtra1:
    s_mov_b32 s40, 1
    v_cmp_lt_i32 s[58:59], 27, v48
    v_cmp_lt_i32 s[60:61], 27, v49
    v_cmp_lt_i32 s[62:63], 36, v48
    v_cmp_lt_i32 s[64:65], 36, v49
    v_cndmask_b32 v31, v1, v50, s[58:59]
    v_cndmask_b32 v35, v1, v51, s[60:61]
    v_cndmask_b32 v39, v1, v50, s[62:63]
    v_cndmask_b32 v43, v1, v51, s[64:65]
    buffer_load_dwordx3 v[28:30], v31, s[12:15], 0 offen offset:324 sc1
    buffer_load_dwordx3 v[32:34], v35, s[12:15], 0 offen offset:324 sc1
    buffer_load_dwordx3 v[36:38], v39, s[12:15], 0 offen offset:432 sc1
    buffer_load_dwordx3 v[40:42], v43, s[12:15], 0 offen offset:432 sc1
    s_branch L2_xtra1r
L2_more:
    v_mov_b32 v2, 256
    ds_write_b32 v2, v99
    s_branch L2_morer
L2_xtra2:
    s_mov_b64 exec, s[58:59]
    v_lshrrev_b32 v31, 24, v30
    ds_add_rtn_u32 v31, v31, v99 offset:0
    s_mov_b64 exec, s[60:61]
    v_lshrrev_b32 v35, 24, v34
    ds_add_rtn_u32 v35, v35, v99 offset:0
    s_mov_b64 exec, s[62:63]
    v_lshrrev_b32 v39, 24, v38
    ds_add_rtn_u32 v39, v39, v99 offset:0
    s_mov_b64 exec, s[64:65]
    v_lshrrev_b32 v43, 24, v42
    ds_add_rtn_u32 v43, v43, v99 offset:0
    s_waitcnt lgkmcnt(0)
    s_mov_b64 exec, s[58:59]
    v_min_u32 v100, 22732, v31
    v_and_b32 v1, s37, v30
    v_lshlrev_b32 v102, 1, v100
    ds_write_b32 v100, v1 offset:6656
    ds_write_b64 v102, v[28:29] offset:29488
    s_mov_b64 exec, s[60:61]
    v_min_u32 v101, 22732, v35
    v_and_b32 v2, s37, v34
    v_lshlrev_b32 v103, 1, v101
    ds_write_b32 v101, v2 offset:6656
    ds_write_b64 v103, v[32:33] offset:29488
    s_mov_b64 exec, s[62:63]
    v_min_u32 v100, 22732, v39
    v_and_b32 v1, s37, v38
    v_lshlrev_b32 v102, 1, v100
    ds_write_b32 v100, v1 offset:6656
    ds_write_b64 v102, v[36:37] offset:29488
    s_mov_b64 exec, s[64:65]
    v_min_u32 v101, 22732, v43
    v_and_b32 v2, s37, v42
    v_lshlrev_b32 v103, 1, v101
    ds_write_b32 v101, v2 offset:6656
    ds_write_b64 v103, v[40:41] offset:29488
    s_branch L2_xtra2r
L2_start:
    s_mov_b32 s30, 0
    s_movk_i32 s31, 45
    v_mov_b32 v97, 0
    s_cmp_ge_u32 s28, 8
    s_cbranch_scc1 L2_gemm
L2_pass:
    v_lshlrev_b32 v2, 2, v98
    v_mul_u32_u24 v3, 464, v98
    ds_write_b32 v2, v3 offset:0
    v_mov_b32 v2, 256
    v_mov_b32 v3, 0
    ds_write_b32 v2, v3
    v_mul_u32_u24 v2, 57, v98
    v_lshrrev_b32 v2, 9, v2
    v_min_u32 v2, 6, v2
    s_mul_i32 s3, s28, 7
    v_add_u32 v1, s3, v2
    s_lshl_b32 s3, s29, 3
    s_add_u32 s3, s3, 18874368
    v_lshl_add_u32 v124, v1, 12, s3
    v_mul_u32_u24 v2, 9, v2
    v_sub_u32 v2, v98, v2
    v_add_u32 v2, s30, v2
    v_mul_u32_u24 v1, 86016, v1
    v_add_u32 v1, 8388608, v1
    v_mad_u32_u24 v50, v2, 12, v1
    v_add_u32 v51, 43008, v50
    s_add_u32 s39, s30, s31
    s_mov_b32 s3, 1073741824
    v_mov_b32 v1, s3
    v_writelane_b32 v2, s3, 63
    s_mov_b32 s41, 40000
    s_waitcnt lgkmcnt(0)
    s_barrier
    s_branch L2_poll
L2_compact:
    s_cmp_le_u32 s36, 710
    s_cbranch_scc1 L2_compact2
    s_movk_i32 s31, 23
    s_waitcnt vmcnt(0) lgkmcnt(0)
    s_barrier
    s_branch L2_pass
L2_compact2:
    v_mov_b32 v114, v100
    v_mov_b32 v115, v101
    s_mov_b32 s3, 22736
    v_lshlrev_b32 v3, 5, v1
    v_writelane_b32 v3, s3, 49
    s_lshl_b32 s3, s28, 5
    v_add_u32 v3, s3, v3
    v_sub_u32 v2, v3, v118
    v_mov_b32 v118, v3
    v_add_u32 v106, v106, v2
    v_add_u32 v107, v107, v2
    v_lshrrev_b32 v52, 24, v6
    ds_bpermute_b32 v52, v52, v2
    v_lshrrev_b32 v53, 24, v10
    ds_bpermute_b32 v53, v53, v2
    v_lshrrev_b32 v54, 24, v14
    ds_bpermute_b32 v54, v54, v2
    v_lshrrev_b32 v55, 24, v18
    ds_bpermute_b32 v55, v55, v2
    v_lshrrev_b32 v56, 24, v22
    ds_bpermute_b32 v56, v56, v2
    v_lshrrev_b32 v57, 24, v26
    ds_bpermute_b32 v57, v57, v2
    v_lshrrev_b32 v58, 24, v30
    ds_bpermute_b32 v58, v58, v2
    v_lshrrev_b32 v59, 24, v34
    ds_bpermute_b32 v59, v59, v2
    v_lshrrev_b32 v60, 24, v38
    ds_bpermute_b32 v60, v60, v2
    v_lshrrev_b32 v61, 24, v42
    ds_bpermute_b32 v61, v61, v2
    s_waitcnt lgkmcnt(0)
    v_add_u32 v7, v7, v52
    v_add_u32 v11, v11, v53
    v_add_u32 v15, v15, v54
    v_add_u32 v19, v19, v55
    v_add_u32 v23, v23, v56
    v_add_u32 v27, v27, v57
    v_add_u32 v31, v31, v58
    v_add_u32 v35, v35, v59
    v_add_u32 v39, v39, v60
    v_add_u32 v43, v43, v61
    s_mov_b64 exec, s[46:47]
    v_min_u32 v100, 22732, v7
    v_and_b32 v1, s37, v6
    v_lshlrev_b32 v102, 1, v100
    ds_write_b32 v100, v1 offset:6656
    ds_write_b64 v102, v[4:5] offset:29488
    s_mov_b64 exec, s[48:49]
    v_min_u32 v101, 22732, v11
    v_and_b32 v2, s37, v10
    v_lshlrev_b32 v103, 1, v101
    ds_write_b32 v101, v2 offset:6656
    ds_write_b64 v103, v[8:9] offset:29488
    s_mov_b64 exec, s[50:51]
    v_min_u32 v100, 22732, v15
    v_and_b32 v1, s37, v14
    v_lshlrev_b32 v102, 1, v100
    ds_write_b32 v100, v1 offset:6656
    ds_write_b64 v102, v[12:13] offset:29488
    s_mov_b64 exec, s[52:53]
    v_min_u32 v101, 22732, v19
    v_and_b32 v2, s37, v18
    v_lshlrev_b32 v103, 1, v101
    ds_write_b32 v101, v2 offset:6656
    ds_write_b64 v103, v[16:17] offset:29488
    s_mov_b64 exec, s[54:55]
    v_min_u32 v100, 22732, v23
    v_and_b32 v1, s37, v22
    v_lshlrev_b32 v102, 1, v100
    ds_write_b32 v100, v1 offset:6656
    ds_write_b64 v102, v[20:21] offset:29488
    s_mov_b64 exec, s[56:57]
    v_min_u32 v101, 22732, v27
    v_and_b32 v2, s37, v26
    v_lshlrev_b32 v103, 1, v101
    ds_write_b32 v101, v2 offset:6656
    ds_write_b64 v103, v[24:25] offset:29488
    s_cmp_eq_u32 s40, 0
    s_cbranch_scc1 L2_noxtra3
    s_mov_b64 exec, s[58:59]
    v_min_u32 v100, 22732, v31
    v_and_b32 v1, s37, v30
    v_lshlrev_b32 v102, 1, v100
    ds_write_b32 v100, v1 offset:6656
    ds_write_b64 v102, v[28:29] offset:29488
    s_mov_b64 exec, s[60:61]
    v_min_u32 v101, 22732, v35
    v_and_b32 v2, s37, v34
    v_lshlrev_b32 v103, 1, v101
    ds_write_b32 v101, v2 offset:6656
    ds_write_b64 v103, v[32:33] offset:29488
    s_mov_b64 exec, s[62:63]
    v_min_u32 v100, 22732, v39
    v_and_b32 v1, s37, v38
    v_lshlrev_b32 v102, 1, v100
    ds_write_b32 v100, v1 offset:6656
    ds_write_b64 v102, v[36:37] offset:29488
    s_mov_b64 exec, s[64:65]
    v_min_u32 v101, 22732, v43
    v_and_b32 v2, s37, v42
    v_lshlrev_b32 v103, 1, v101
    ds_write_b32 v101, v2 offset:6656
    ds_write_b64 v103, v[40:41] offset:29488
L2_noxtra3:
    s_mov_b64 exec, -1
    v_mov_b32 v100, v114
    s_mov_b32 s3, s28
L2_dloop:
    v_cmp_lt_u32 vcc, s3, v114
    s_and_b64 exec, exec, vcc
    s_cbranch_execz L2_fits
    ds_write_b64 v115, v[118:119] offset:512
    v_add_u32 v115, 128, v115
    v_add_u32 v118, 512, v118
    s_add_u32 s3, s3, 16
    s_branch L2_dloop
L2_safe:
    s_setprio 3
L2_loops:
    s_cmp_gt_u32 s35, 6
    s_cbranch_scc1 L2_prs
    s_setprio 2
    s_cmp_gt_u32 s35, 4
    s_cbranch_scc1 L2_prs
    s_setprio 1
    s_cmp_gt_u32 s35, 2
    s_cbranch_scc1 L2_prs
    s_setprio 0
L2_prs:
    s_waitcnt vmcnt(0) lgkmcnt(0)
    v_mfma_f32_32x32x16_bf16 v[52:67], v[84:87], v[88:91], v[20:35]
    s_nop 4
    v_cvt_f64_f32 v[108:109], v106
    v_cvt_f64_f32 v[110:111], v107
    ds_add_f64 v113, v[108:109] offset:0
    ds_add_f64 v113, v[110:111] offset:256
    v_mad_u32_u24 v122, v122, v92, v123
    v_add_u32 v113, v119, v96
    ds_read_b64 v[84:85], v122 offset:29488
    ds_read_b64 v[90:91], v113 offset:512
    s_cmp_eq_u32 s35, 1
    s_cbranch_scc1 L2_nls0
    buffer_load_dword v36, v4, s[8:11], 0 offen offset:0
    buffer_load_dword v37, v4, s[8:11], 0 offen offset:4
    buffer_load_dword v38, v5, s[8:11], 0 offen offset:0
    buffer_load_dword v39, v5, s[8:11], 0 offen offset:4
    buffer_load_dword v40, v6, s[8:11], 0 offen offset:0
    buffer_load_dword v41, v6, s[8:11], 0 offen offset:4
    buffer_load_dword v42, v7, s[8:11], 0 offen offset:0
    buffer_load_dword v43, v7, s[8:11], 0 offen offset:4
    buffer_load_dword v44, v8, s[8:11], 0 offen offset:0
    buffer_load_dword v45, v8, s[8:11], 0 offen offset:4
    buffer_load_dword v46, v9, s[8:11], 0 offen offset:0
    buffer_load_dword v47, v9, s[8:11], 0 offen offset:4
    buffer_load_dword v48, v10, s[8:11], 0 offen offset:0
    buffer_load_dword v49, v10, s[8:11], 0 offen offset:4
    buffer_load_dword v50, v11, s[8:11], 0 offen offset:0
    buffer_load_dword v51, v11, s[8:11], 0 offen offset:4
L2_nls0:
    ds_read_b128 v[4:7], v118 offset:6656
    ds_read_b128 v[8:11], v118 offset:6672
    ds_read2_b32 v[118:119], v116 offset0:12 offset1:9
    ds_read_b32 v122, v117 offset:32
    v_lshlrev_b64 v[20:21], 16, v[20:21]
    v_lshlrev_b64 v[22:23], 16, v[22:23]
    v_lshlrev_b64 v[24:25], 16, v[24:25]
    v_lshlrev_b64 v[26:27], 16, v[26:27]
    v_lshlrev_b64 v[28:29], 16, v[28:29]
    v_lshlrev_b64 v[30:31], 16, v[30:31]
    v_lshlrev_b64 v[32:33], 16, v[32:33]
    v_lshlrev_b64 v[34:35], 16, v[34:35]
    v_exp_f32 v52, v52
    v_exp_f32 v53, v53
    v_exp_f32 v54, v54
    v_exp_f32 v55, v55
    v_exp_f32 v56, v56
    v_exp_f32 v57, v57
    v_exp_f32 v58, v58
    v_exp_f32 v59, v59
    v_exp_f32 v60, v60
    v_exp_f32 v61, v61
    v_exp_f32 v62, v62
    v_exp_f32 v63, v63
    v_exp_f32 v64, v64
    v_exp_f32 v65, v65
    v_exp_f32 v66, v66
    v_exp_f32 v67, v67
    v_pk_add_f32 v[52:53], v[52:53], 1.0 op_sel_hi:[1,0]
    v_pk_add_f32 v[54:55], v[54:55], 1.0 op_sel_hi:[1,0]
    v_pk_add_f32 v[56:57], v[56:57], 1.0 op_sel_hi:[1,0]
    v_pk_add_f32 v[58:59], v[58:59], 1.0 op_sel_hi:[1,0]
    v_pk_add_f32 v[60:61], v[60:61], 1.0 op_sel_hi:[1,0]
    v_pk_add_f32 v[62:63], v[62:63], 1.0 op_sel_hi:[1,0]
    v_pk_add_f32 v[64:65], v[64:65], 1.0 op_sel_hi:[1,0]
    v_pk_add_f32 v[66:67], v[66:67], 1.0 op_sel_hi:[1,0]
    v_rcp_f32 v52, v52
    v_rcp_f32 v53, v53
    v_rcp_f32 v54, v54
    v_rcp_f32 v55, v55
    v_rcp_f32 v56, v56
    v_rcp_f32 v57, v57
    v_rcp_f32 v58, v58
    v_rcp_f32 v59, v59
    v_rcp_f32 v60, v60
    v_rcp_f32 v61, v61
    v_rcp_f32 v62, v62
    v_rcp_f32 v63, v63
    v_rcp_f32 v64, v64
    v_rcp_f32 v65, v65
    v_rcp_f32 v66, v66
    v_rcp_f32 v67, v67
    v_pk_mul_f32 v[106:107], v[52:53], v[20:21]
    v_pk_fma_f32 v[106:107], v[54:55], v[22:23], v[106:107]
    v_pk_fma_f32 v[106:107], v[56:57], v[24:25], v[106:107]
    v_pk_fma_f32 v[106:107], v[58:59], v[26:27], v[106:107]
    v_pk_fma_f32 v[106:107], v[60:61], v[28:29], v[106:107]
    v_pk_fma_f32 v[106:107], v[62:63], v[30:31], v[106:107]
    v_pk_fma_f32 v[106:107], v[64:65], v[32:33], v[106:107]
    v_pk_fma_f32 v[106:107], v[66:67], v[34:35], v[106:107]
    s_sub_u32 s35, s35, 1
    s_cmp_eq_u32 s35, 0
    s_cbranch_scc1 L2_x0s
    s_waitcnt vmcnt(0) lgkmcnt(0)
    v_mfma_f32_32x32x16_bf16 v[52:67], v[84:87], v[88:91], v[36:51]
    s_nop 4
    v_cvt_f64_f32 v[108:109], v106
    v_cvt_f64_f32 v[110:111], v107
    ds_add_f64 v112, v[108:109] offset:0
    ds_add_f64 v112, v[110:111] offset:256
    v_mad_u32_u24 v122, v122, v92, v123
    v_add_u32 v112, v119, v96
    ds_read_b64 v[84:85], v122 offset:29488
    ds_read_b64 v[90:91], v112 offset:512
    s_cmp_eq_u32 s35, 1
    s_cbranch_scc1 L2_nls1
    buffer_load_dword v20, v4, s[8:11], 0 offen offset:0
    buffer_load_dword v21, v4, s[8:11], 0 offen offset:4
    buffer_load_dword v22, v5, s[8:11], 0 offen offset:0
    buffer_load_dword v23, v5, s[8:11], 0 offen offset:4
    buffer_load_dword v24, v6, s[8:11], 0 offen offset:0
    buffer_load_dword v25, v6, s[8:11], 0 offen offset:4
    buffer_load_dword v26, v7, s[8:11], 0 offen offset:0
    buffer_load_dword v27, v7, s[8:11], 0 offen offset:4
    buffer_load_dword v28, v8, s[8:11], 0 offen offset:0
    buffer_load_dword v29, v8, s[8:11], 0 offen offset:4
    buffer_load_dword v30, v9, s[8:11], 0 offen offset:0
    buffer_load_dword v31, v9, s[8:11], 0 offen offset:4
    buffer_load_dword v32, v10, s[8:11], 0 offen offset:0
    buffer_load_dword v33, v10, s[8:11], 0 offen offset:4
    buffer_load_dword v34, v11, s[8:11], 0 offen offset:0
    buffer_load_dword v35, v11, s[8:11], 0 offen offset:4
L2_nls1:
    ds_read_b128 v[4:7], v118 offset:6656
    ds_read_b128 v[8:11], v118 offset:6672
    ds_read2_b32 v[118:119], v116 offset0:16 offset1:13
    ds_read_b32 v122, v117 offset:48
    v_lshl_add_u64 v[116:117], v[116:117], 0, v[94:95]
    v_lshlrev_b64 v[36:37], 16, v[36:37]
    v_lshlrev_b64 v[38:39], 16, v[38:39]
    v_lshlrev_b64 v[40:41], 16, v[40:41]
    v_lshlrev_b64 v[42:43], 16, v[42:43]
    v_lshlrev_b64 v[44:45], 16, v[44:45]
    v_lshlrev_b64 v[46:47], 16, v[46:47]
    v_lshlrev_b64 v[48:49], 16, v[48:49]
    v_lshlrev_b64 v[50:51], 16, v[50:51]
    v_exp_f32 v52, v52
    v_exp_f32 v53, v53
    v_exp_f32 v54, v54
    v_exp_f32 v55, v55
    v_exp_f32 v56, v56
    v_exp_f32 v57, v57
    v_exp_f32 v58, v58
    v_exp_f32 v59, v59
    v_exp_f32 v60, v60
    v_exp_f32 v61, v61
    v_exp_f32 v62, v62
    v_exp_f32 v63, v63
    v_exp_f32 v64, v64
    v_exp_f32 v65, v65
    v_exp_f32 v66, v66
    v_exp_f32 v67, v67
    v_pk_add_f32 v[52:53], v[52:53], 1.0 op_sel_hi:[1,0]
    v_pk_add_f32 v[54:55], v[54:55], 1.0 op_sel_hi:[1,0]
    v_pk_add_f32 v[56:57], v[56:57], 1.0 op_sel_hi:[1,0]
    v_pk_add_f32 v[58:59], v[58:59], 1.0 op_sel_hi:[1,0]
    v_pk_add_f32 v[60:61], v[60:61], 1.0 op_sel_hi:[1,0]
    v_pk_add_f32 v[62:63], v[62:63], 1.0 op_sel_hi:[1,0]
    v_pk_add_f32 v[64:65], v[64:65], 1.0 op_sel_hi:[1,0]
    v_pk_add_f32 v[66:67], v[66:67], 1.0 op_sel_hi:[1,0]
    v_rcp_f32 v52, v52
    v_rcp_f32 v53, v53
    v_rcp_f32 v54, v54
    v_rcp_f32 v55, v55
    v_rcp_f32 v56, v56
    v_rcp_f32 v57, v57
    v_rcp_f32 v58, v58
    v_rcp_f32 v59, v59
    v_rcp_f32 v60, v60
    v_rcp_f32 v61, v61
    v_rcp_f32 v62, v62
    v_rcp_f32 v63, v63
    v_rcp_f32 v64, v64
    v_rcp_f32 v65, v65
    v_rcp_f32 v66, v66
    v_rcp_f32 v67, v67
    v_pk_mul_f32 v[106:107], v[52:53], v[36:37]
    v_pk_fma_f32 v[106:107], v[54:55], v[38:39], v[106:107]
    v_pk_fma_f32 v[106:107], v[56:57], v[40:41], v[106:107]
    v_pk_fma_f32 v[106:107], v[58:59], v[42:43], v[106:107]
    v_pk_fma_f32 v[106:107], v[60:61], v[44:45], v[106:107]
    v_pk_fma_f32 v[106:107], v[62:63], v[46:47], v[106:107]
    v_pk_fma_f32 v[106:107], v[64:65], v[48:49], v[106:107]
    v_pk_fma_f32 v[106:107], v[66:67], v[50:51], v[106:107]
    s_sub_u32 s35, s35, 1
    s_cmp_eq_u32 s35, 0
    s_cbranch_scc0 L2_loops
    v_mov_b64 v[34:35], v[50:51]
    v_mov_b32 v112, v113
L2_x0s:
    s_nop 4
    v_cvt_f64_f32 v[108:109], v106
    v_cvt_f64_f32 v[110:111], v107
    ds_add_f64 v112, v[108:109] offset:0
    ds_add_f64 v112, v[110:111] offset:256
    s_setprio 0
    s_branch L2_done
.section .rodata,"a"
.p2align 6
.amdhsa_kernel gather_scatter__edge_featured_mpnn_egc__graph_kernel
  .amdhsa_next_free_vgpr 128
  .amdhsa_next_free_sgpr 92
  .amdhsa_accum_offset 128
  .amdhsa_group_segment_fixed_size 0
  .amdhsa_kernarg_size 80
  .amdhsa_user_sgpr_count 2
  .amdhsa_user_sgpr_kernarg_segment_ptr 1
  .amdhsa_system_sgpr_workgroup_id_x 1
  .amdhsa_float_denorm_mode_32 3
.end_amdhsa_kernel
```
